```python
import torch

def _softmax(x, axis=-1):
    return torch.softmax(x, dim=axis)
def _gelu(x):
    return torch.nn.functional.gelu(x, approximate="tanh")
def _silu(x):
    return torch.nn.functional.silu(x)
def _sigmoid(x):
    return torch.sigmoid(x)
def _layernorm(x, axis=-1, eps=1e-5):
    m = x.mean(dim=axis, keepdim=True)
    v = x.var(dim=axis, keepdim=True, unbiased=False)
    return (x - m) / torch.sqrt(v + eps)
def _scatter_add(tgt, idx, src, axis=0):
    return tgt.clone().index_add_(axis, idx, src)
def _segment_sum(src, seg, n):
    out = torch.zeros((n,) + src.shape[1:], dtype=src.dtype)
    return out.index_add_(0, seg, src)
def _pad(x, pw):
    flat = tuple(v for pair in reversed(pw) for v in pair)
    return torch.nn.functional.pad(x, flat)

kernel_name = 'recurrent_scan__spectral_gfnet__glu_gated_reglu__prompt'

def setup_inputs():

    _w = (lambda a: (lambda t: t.to(torch.bfloat16) if t.is_floating_point() else t)(torch.as_tensor(a)))
    def _A_setup():
        B, S, D = 1, 2048, 512
        Df = D // 2 + 1
        return {
            "x": _w((lambda *s: torch.randn(*s, dtype=torch.bfloat16) * 0.2)(B, S, D)),
            "w_r": _w((lambda *s: torch.randn(*s, dtype=torch.bfloat16) * 1.6)(S, Df) * 0.02),
            "w_i": _w((lambda *s: torch.randn(*s, dtype=torch.bfloat16) * 1.6)(S, Df) * 0.02),
        }
    _A_in = _A_setup()

    def _B_setup():
        B, S, D, F = 1, 2048, 512, 1792
        return {
            "x": _w((lambda *s: torch.randn(*s, dtype=torch.bfloat16) * 0.2)(B, S, D)),
            "W_gate": _w((lambda *s: torch.randn(*s, dtype=torch.bfloat16) * 0.8)(D, F) * (2.0 / D) ** 0.5),
            "W_up": _w((lambda *s: torch.randn(*s, dtype=torch.bfloat16) * 0.8)(D, F) * (2.0 / D) ** 0.5),
            "W_down": _w((lambda *s: torch.randn(*s, dtype=torch.bfloat16) * 0.8)(F, D) * (1.0 / F) ** 0.5),
        }
    _B_in = _B_setup()

    return {
        "A_x": _A_in["x"],
        "A_w_r": _A_in["w_r"],
        "A_w_i": _A_in["w_i"],
        "B_x": _B_in["x"],
        "B_W_gate": _B_in["W_gate"],
        "B_W_up": _B_in["W_up"],
        "B_W_down": _B_in["W_down"],
    }

def reference(A_x, A_w_r, A_w_i, B_x, B_W_gate, B_W_up, B_W_down):
    def _A_ref(x, w_r, w_i):
        B, S, D = x.shape
        X = (lambda x, axes=(-2,-1): torch.fft.rfft2(x.float(), dim=axes))(x, axes=(-2, -1))
        W = w_r + 1j * w_i
        X = X * W
        y = (lambda x, s, axes=(-2,-1): torch.fft.irfft2(x, s=s, dim=axes).to(torch.bfloat16))(X, (S, D), axes=(-2, -1))
        return y

    def _B_ref(x, W_gate, W_up, W_down):
        gate = torch.einsum("bsd,df->bsf", x, W_gate)
        up = torch.einsum("bsd,df->bsf", x, W_up)
        gate = gate * (lambda x, dt: x.to(dt))(gate > 0, gate.dtype)
        h = gate * up
        return torch.einsum("bsf,fd->bsd", h, W_down)

    x = A_x
    xn = _layernorm(x, axis=-1)
    s = _A_ref(xn, A_w_r, A_w_i)
    g = _silu(_B_ref(xn, B_W_gate, B_W_up, B_W_down))
    return x + s * g
```

```asm
; @launch kernel=l0_kernel grid=(256,1,1) block=(512,1,1) lds=53504
; @launch kernel=l1_kernel grid=(481,1,1) block=(256,1,1) lds=65536
; @launch kernel=l2_kernel grid=(256,1,1) block=(256,1,1) lds=135168
.amdgcn_target "amdgcn-amd-amdhsa--gfx950"
.text
.globl l0_kernel
.p2align 8
.type l0_kernel,@function
l0_kernel:
    s_cmp_ge_u32 s2, 256
    s_cbranch_scc1 L0_end
    s_getpc_b64 s[68:69]
    v_and_b32 v62, 63, v0
    v_lshlrev_b32 v62, 7, v62
    v_min_u32 v62, L0_end-l0_kernel, v62
    global_load_dword v135, v62, s[68:69]
    s_cmp_ge_u32 s2, 128
    s_cbranch_scc1 L0_aux
    s_load_dwordx2 s[4:5], s[0:1], 0
    s_load_dwordx2 s[10:11], s[0:1], 72
    s_load_dwordx4 s[52:55], s[0:1], 32
    v_and_b32 v1, 31, v0
    v_lshrrev_b32 v2, 5, v0
    s_lshl_b32 s3, s2, 14
    v_lshlrev_b32 v3, 10, v2
    v_lshl_add_u32 v3, v1, 2, v3
    s_mov_b32 s30, 0x3f3504f3
    s_mov_b32 s31, 0x3f3504f3
    s_mov_b32 s32, 0.5
    s_mov_b32 s33, 0.5
    s_waitcnt lgkmcnt(0)
    s_mov_b32 s12, s4
    s_and_b32 s13, s5, 0xffff
    s_mov_b32 s14, 0x200000
    s_mov_b32 s15, 0x00020000
    buffer_load_dword v8, v3, s[12:15], s3 offen offset:0
    buffer_load_dword v9, v3, s[12:15], s3 offen offset:128
    buffer_load_dword v10, v3, s[12:15], s3 offen offset:256
    buffer_load_dword v11, v3, s[12:15], s3 offen offset:384
    buffer_load_dword v12, v3, s[12:15], s3 offen offset:512
    buffer_load_dword v13, v3, s[12:15], s3 offen offset:640
    buffer_load_dword v14, v3, s[12:15], s3 offen offset:768
    buffer_load_dword v15, v3, s[12:15], s3 offen offset:896
    s_mov_b32 s24, s10
    s_and_b32 s25, s11, 0xffff
    s_mov_b32 s26, 0x10000000
    s_mov_b32 s27, 0x00020000
    s_mov_b32 s60, s52
    s_and_b32 s61, s53, 0xffff
    s_mov_b32 s62, 0x1c0000
    s_mov_b32 s63, 0x00020000
    v_bfe_u32 v62, v0, 4, 5
    v_and_b32 v63, 7, v0
    v_min_u32 v63, 6, v63
    v_mul_u32_u24 v62, 3584, v62
    v_lshl_add_u32 v62, v63, 7, v62
    s_lshr_b32 s58, s2, 3
    s_mul_i32 s58, s58, 114688
    s_bfe_u32 s59, s2, 0x20001
    s_mul_i32 s59, s59, 896
    s_add_u32 s58, s58, s59
    v_mov_b32 v133, v62
    s_mov_b32 s57, s58
    v_cvt_f32_u32 v62, v1
    v_mul_f32 v62, 0x3b800000, v62
    v_mul_f32 v35, 1.0, v62
    v_mul_f32 v37, 2.0, v62
    v_mul_f32 v39, 0x40400000, v62
    v_mul_f32 v41, 4.0, v62
    v_mul_f32 v43, 0x40a00000, v62
    v_mul_f32 v45, 0x40c00000, v62
    v_mul_f32 v47, 0x40e00000, v62
    v_cos_f32 v34, v35
    v_sin_f32 v35, -v35
    v_cos_f32 v36, v37
    v_sin_f32 v37, -v37
    v_cos_f32 v38, v39
    v_sin_f32 v39, -v39
    v_cos_f32 v40, v41
    v_sin_f32 v41, -v41
    v_cos_f32 v42, v43
    v_sin_f32 v43, -v43
    v_cos_f32 v44, v45
    v_sin_f32 v45, -v45
    v_cos_f32 v46, v47
    v_sin_f32 v47, -v47
    v_and_b32 v62, 3, v1
    v_cvt_f32_u32 v62, v62
    v_mul_f32 v62, 0x3d000000, v62
    v_mul_f32 v49, 1.0, v62
    v_mul_f32 v51, 2.0, v62
    v_mul_f32 v53, 0x40400000, v62
    v_mul_f32 v55, 4.0, v62
    v_mul_f32 v57, 0x40a00000, v62
    v_mul_f32 v59, 0x40c00000, v62
    v_mul_f32 v61, 0x40e00000, v62
    v_cos_f32 v48, v49
    v_sin_f32 v49, -v49
    v_cos_f32 v50, v51
    v_sin_f32 v51, -v51
    v_cos_f32 v52, v53
    v_sin_f32 v53, -v53
    v_cos_f32 v54, v55
    v_sin_f32 v55, -v55
    v_cos_f32 v56, v57
    v_sin_f32 v57, -v57
    v_cos_f32 v58, v59
    v_sin_f32 v59, -v59
    v_cos_f32 v60, v61
    v_sin_f32 v61, -v61
    v_lshrrev_b32 v66, 2, v0
    v_cvt_f32_u32 v62, v66
    v_mul_f32 v62, 0x3b000000, v62
    v_sin_f32 v16, v62
    v_cos_f32 v17, v62
    v_mul_f32 v16, -0.5, v16
    v_mul_f32 v17, -0.5, v17
    v_mul_u32_u24 v75, 2320, v2
    v_lshl_add_u32 v68, v1, 3, v75
    v_lshrrev_b32 v76, 2, v1
    v_and_b32 v77, 3, v1
    v_mul_u32_u24 v78, 288, v76
    v_lshl_add_u32 v78, v77, 3, v78
    v_add_u32 v69, v78, v75
    v_lshrrev_b32 v76, 3, v1
    v_and_b32 v77, 7, v1
    v_mul_u32_u24 v78, 264, v76
    v_lshl_add_u32 v78, v77, 5, v78
    v_add_u32 v71, v78, v75
    v_and_b32 v76, 3, v0
    v_mul_u32_u24 v77, 9280, v76
    v_lshl_add_u32 v73, v66, 3, v77
    v_sub_u32 v78, 256, v66
    v_and_b32 v79, 255, v78
    v_lshl_add_u32 v74, v79, 3, v77
    v_lshlrev_b32 v76, 4, v76
    v_lshl_add_u32 v79, v66, 6, v76
    v_cmp_eq_u32 vcc, 0, v66
    v_mov_b32 v77, 128
    s_nop 0
    v_cndmask_b32 v78, v78, v77, vcc
    v_lshl_add_u32 v80, v78, 6, v76
    s_lshl_b32 s44, s2, 14
    s_add_u32 s44, s44, 2097152
    v_and_b32 v76, 15, v1
    v_xor_b32 v76, v76, v2
    v_lshlrev_b32 v76, 4, v76
    v_lshl_add_u32 v82, v1, 9, v76
    v_add_u32 v82, 37120, v82
    v_lshlrev_b32 v83, 4, v0
    v_add_u32 v83, 37120, v83
    v_and_b32 v76, 15, v0
    v_xor_b32 v76, v76, v2
    v_lshrrev_b32 v77, 4, v0
    v_lshlrev_b32 v77, 9, v77
    v_lshl_add_u32 v20, v76, 4, v77
    s_lshr_b32 s45, s2, 1
    s_lshl_b32 s45, s45, 15
    s_and_b32 s46, s2, 1
    s_lshl_b32 s46, s46, 8
    s_add_u32 s45, s45, s46
    s_add_u32 s46, s45, 16384
    s_waitcnt vmcnt(0)
    buffer_load_dword v134, v133, s[60:63], s57 offen
    s_mov_b32 s64, s54
    s_and_b32 s65, s55, 0xffff
    s_mov_b32 s66, 0x1c0000
    s_mov_b32 s67, 0x00020000
    v_cmp_gt_u32 vcc, 256, v0
    s_cbranch_vccz L0_noup
    buffer_load_dword v132, v133, s[64:67], s57 offen
L0_noup:
    v_lshlrev_b32 v84, 16, v8
    v_and_b32 v85, 0xffff0000, v8
    v_lshlrev_b32 v86, 16, v9
    v_and_b32 v87, 0xffff0000, v9
    v_lshlrev_b32 v88, 16, v10
    v_and_b32 v89, 0xffff0000, v10
    v_lshlrev_b32 v90, 16, v11
    v_and_b32 v91, 0xffff0000, v11
    v_lshlrev_b32 v92, 16, v12
    v_and_b32 v93, 0xffff0000, v12
    v_lshlrev_b32 v94, 16, v13
    v_and_b32 v95, 0xffff0000, v13
    v_lshlrev_b32 v96, 16, v14
    v_and_b32 v97, 0xffff0000, v14
    v_lshlrev_b32 v98, 16, v15
    v_and_b32 v99, 0xffff0000, v15
    v_pk_add_f32 v[100:101], v[84:85], v[92:93]
    v_pk_add_f32 v[102:103], v[86:87], v[94:95]
    v_pk_add_f32 v[104:105], v[88:89], v[96:97]
    v_pk_add_f32 v[106:107], v[90:91], v[98:99]
    v_pk_add_f32 v[100:101], v[100:101], v[104:105]
    v_pk_add_f32 v[102:103], v[102:103], v[106:107]
    v_pk_add_f32 v[100:101], v[100:101], v[102:103]
    v_add_f32 v102, v100, v101
    s_nop 1
    v_add_f32_dpp v102, v102, v102 quad_perm:[1,0,3,2] row_mask:0xf bank_mask:0xf
    s_nop 1
    v_add_f32_dpp v102, v102, v102 quad_perm:[2,3,0,1] row_mask:0xf bank_mask:0xf
    s_nop 1
    v_add_f32_dpp v102, v102, v102 row_half_mirror row_mask:0xf bank_mask:0xf
    s_nop 1
    v_add_f32_dpp v102, v102, v102 row_mirror row_mask:0xf bank_mask:0xf
    v_mov_b32 v103, v102
    s_nop 1
    v_permlane16_swap_b32 v102, v103
    v_add_f32 v102, v102, v103
    v_mul_f32 v102, 0x3b000000, v102
    v_pk_add_f32 v[108:109], v[84:85], v[102:103] op_sel_hi:[1,0] neg_lo:[0,1] neg_hi:[0,1]
    v_pk_add_f32 v[110:111], v[86:87], v[102:103] op_sel_hi:[1,0] neg_lo:[0,1] neg_hi:[0,1]
    v_pk_add_f32 v[112:113], v[88:89], v[102:103] op_sel_hi:[1,0] neg_lo:[0,1] neg_hi:[0,1]
    v_pk_add_f32 v[114:115], v[90:91], v[102:103] op_sel_hi:[1,0] neg_lo:[0,1] neg_hi:[0,1]
    v_pk_add_f32 v[116:117], v[92:93], v[102:103] op_sel_hi:[1,0] neg_lo:[0,1] neg_hi:[0,1]
    v_pk_add_f32 v[118:119], v[94:95], v[102:103] op_sel_hi:[1,0] neg_lo:[0,1] neg_hi:[0,1]
    v_pk_add_f32 v[120:121], v[96:97], v[102:103] op_sel_hi:[1,0] neg_lo:[0,1] neg_hi:[0,1]
    v_pk_add_f32 v[122:123], v[98:99], v[102:103] op_sel_hi:[1,0] neg_lo:[0,1] neg_hi:[0,1]
    v_pk_mul_f32 v[104:105], v[108:109], v[108:109]
    v_pk_mul_f32 v[106:107], v[110:111], v[110:111]
    v_pk_fma_f32 v[104:105], v[112:113], v[112:113], v[104:105]
    v_pk_fma_f32 v[106:107], v[114:115], v[114:115], v[106:107]
    v_pk_fma_f32 v[104:105], v[116:117], v[116:117], v[104:105]
    v_pk_fma_f32 v[106:107], v[118:119], v[118:119], v[106:107]
    v_pk_fma_f32 v[104:105], v[120:121], v[120:121], v[104:105]
    v_pk_fma_f32 v[106:107], v[122:123], v[122:123], v[106:107]
    v_pk_add_f32 v[104:105], v[104:105], v[106:107]
    v_add_f32 v106, v104, v105
    s_nop 1
    v_add_f32_dpp v106, v106, v106 quad_perm:[1,0,3,2] row_mask:0xf bank_mask:0xf
    s_nop 1
    v_add_f32_dpp v106, v106, v106 quad_perm:[2,3,0,1] row_mask:0xf bank_mask:0xf
    s_nop 1
    v_add_f32_dpp v106, v106, v106 row_half_mirror row_mask:0xf bank_mask:0xf
    s_nop 1
    v_add_f32_dpp v106, v106, v106 row_mirror row_mask:0xf bank_mask:0xf
    v_mov_b32 v107, v106
    s_nop 1
    v_permlane16_swap_b32 v106, v107
    v_add_f32 v106, v106, v107
    v_mul_f32 v106, 0x3b000000, v106
    v_cvt_pk_bf16_f32 v102, v102, v102
    v_and_b32 v102, 0xffff0000, v102
    v_cvt_pk_bf16_f32 v106, v106, v106
    v_and_b32 v106, 0xffff0000, v106
    v_add_f32 v106, 0x37280000, v106
    v_cvt_pk_bf16_f32 v106, v106, v106
    v_and_b32 v106, 0xffff0000, v106
    v_sqrt_f32 v106, v106
    s_nop 0
    v_cvt_pk_bf16_f32 v106, v106, v106
    v_and_b32 v106, 0xffff0000, v106
    v_rcp_f32 v106, v106
    v_pk_add_f32 v[108:109], v[84:85], v[102:103] op_sel_hi:[1,0] neg_lo:[0,1] neg_hi:[0,1]
    v_pk_add_f32 v[110:111], v[86:87], v[102:103] op_sel_hi:[1,0] neg_lo:[0,1] neg_hi:[0,1]
    v_pk_add_f32 v[112:113], v[88:89], v[102:103] op_sel_hi:[1,0] neg_lo:[0,1] neg_hi:[0,1]
    v_pk_add_f32 v[114:115], v[90:91], v[102:103] op_sel_hi:[1,0] neg_lo:[0,1] neg_hi:[0,1]
    v_pk_add_f32 v[116:117], v[92:93], v[102:103] op_sel_hi:[1,0] neg_lo:[0,1] neg_hi:[0,1]
    v_pk_add_f32 v[118:119], v[94:95], v[102:103] op_sel_hi:[1,0] neg_lo:[0,1] neg_hi:[0,1]
    v_pk_add_f32 v[120:121], v[96:97], v[102:103] op_sel_hi:[1,0] neg_lo:[0,1] neg_hi:[0,1]
    v_pk_add_f32 v[122:123], v[98:99], v[102:103] op_sel_hi:[1,0] neg_lo:[0,1] neg_hi:[0,1]
    v_cvt_pk_bf16_f32 v8, v108, v109
    v_cvt_pk_bf16_f32 v9, v110, v111
    v_cvt_pk_bf16_f32 v10, v112, v113
    v_cvt_pk_bf16_f32 v11, v114, v115
    v_cvt_pk_bf16_f32 v12, v116, v117
    v_cvt_pk_bf16_f32 v13, v118, v119
    v_cvt_pk_bf16_f32 v14, v120, v121
    v_cvt_pk_bf16_f32 v15, v122, v123
    v_lshlrev_b32 v108, 16, v8
    v_and_b32 v109, 0xffff0000, v8
    v_lshlrev_b32 v110, 16, v9
    v_and_b32 v111, 0xffff0000, v9
    v_lshlrev_b32 v112, 16, v10
    v_and_b32 v113, 0xffff0000, v10
    v_lshlrev_b32 v114, 16, v11
    v_and_b32 v115, 0xffff0000, v11
    v_lshlrev_b32 v116, 16, v12
    v_and_b32 v117, 0xffff0000, v12
    v_lshlrev_b32 v118, 16, v13
    v_and_b32 v119, 0xffff0000, v13
    v_lshlrev_b32 v120, 16, v14
    v_and_b32 v121, 0xffff0000, v14
    v_lshlrev_b32 v122, 16, v15
    v_and_b32 v123, 0xffff0000, v15
    v_pk_mul_f32 v[108:109], v[108:109], v[106:107] op_sel_hi:[1,0]
    v_pk_mul_f32 v[110:111], v[110:111], v[106:107] op_sel_hi:[1,0]
    v_pk_mul_f32 v[112:113], v[112:113], v[106:107] op_sel_hi:[1,0]
    v_pk_mul_f32 v[114:115], v[114:115], v[106:107] op_sel_hi:[1,0]
    v_pk_mul_f32 v[116:117], v[116:117], v[106:107] op_sel_hi:[1,0]
    v_pk_mul_f32 v[118:119], v[118:119], v[106:107] op_sel_hi:[1,0]
    v_pk_mul_f32 v[120:121], v[120:121], v[106:107] op_sel_hi:[1,0]
    v_pk_mul_f32 v[122:123], v[122:123], v[106:107] op_sel_hi:[1,0]
    v_cvt_pk_bf16_f32 v8, v108, v109
    v_cvt_pk_bf16_f32 v9, v110, v111
    v_cvt_pk_bf16_f32 v10, v112, v113
    v_cvt_pk_bf16_f32 v11, v114, v115
    v_cvt_pk_bf16_f32 v12, v116, v117
    v_cvt_pk_bf16_f32 v13, v118, v119
    v_cvt_pk_bf16_f32 v14, v120, v121
    v_cvt_pk_bf16_f32 v15, v122, v123
    ds_write_b128 v82, v[8:11]
    ds_write_b128 v82, v[12:15] offset:256
    v_lshlrev_b32 v84, 16, v8
    v_and_b32 v85, 0xffff0000, v8
    v_lshlrev_b32 v86, 16, v9
    v_and_b32 v87, 0xffff0000, v9
    v_lshlrev_b32 v88, 16, v10
    v_and_b32 v89, 0xffff0000, v10
    v_lshlrev_b32 v90, 16, v11
    v_and_b32 v91, 0xffff0000, v11
    v_lshlrev_b32 v92, 16, v12
    v_and_b32 v93, 0xffff0000, v12
    v_lshlrev_b32 v94, 16, v13
    v_and_b32 v95, 0xffff0000, v13
    v_lshlrev_b32 v96, 16, v14
    v_and_b32 v97, 0xffff0000, v14
    v_lshlrev_b32 v98, 16, v15
    v_and_b32 v99, 0xffff0000, v15
    s_waitcnt lgkmcnt(0)
    s_barrier
    ds_read_b128 v[24:27], v83
    ds_read_b128 v[28:31], v83 offset:8192
    v_sub_f32 v110, v91, v99
    v_sub_f32 v111, v90, v98
    v_sub_f32 v108, v89, v97
    v_sub_f32 v109, v88, v96
    v_pk_add_f32 v[124:125], v[84:85], v[92:93]
    v_pk_add_f32 v[126:127], v[86:87], v[94:95]
    v_pk_add_f32 v[128:129], v[88:89], v[96:97]
    v_pk_add_f32 v[130:131], v[90:91], v[98:99]
    v_pk_add_f32 v[94:95], v[86:87], v[94:95] neg_lo:[0,1] neg_hi:[0,1]
    v_pk_add_f32 v[92:93], v[84:85], v[92:93] neg_lo:[0,1] neg_hi:[0,1]
    v_sub_f32 v84, v127, v131
    v_sub_f32 v85, v126, v130
    v_pk_add_f32 v[86:87], v[94:95], v[110:111] neg_hi:[0,1]
    v_pk_add_f32 v[88:89], v[94:95], v[110:111] neg_lo:[0,1]
    v_pk_add_f32 v[98:99], v[124:125], v[128:129]
    v_pk_add_f32 v[112:113], v[124:125], v[128:129] neg_lo:[0,1] neg_hi:[0,1]
    v_pk_add_f32 v[114:115], v[126:127], v[130:131]
    v_add_f32 v94, v86, v87
    v_sub_f32 v95, v87, v86
    v_sub_f32 v110, v88, v89
    v_add_f32 v111, v89, v88
    v_pk_add_f32 v[90:91], v[92:93], v[108:109] neg_hi:[0,1]
    v_pk_add_f32 v[96:97], v[92:93], v[108:109] neg_lo:[0,1]
    v_pk_add_f32 v[124:125], v[98:99], v[114:115]
    v_pk_add_f32 v[128:129], v[98:99], v[114:115] neg_lo:[0,1] neg_hi:[0,1]
    v_pk_add_f32 v[126:127], v[112:113], v[84:85] neg_hi:[0,1]
    v_pk_add_f32 v[130:131], v[112:113], v[84:85] neg_lo:[0,1]
    v_pk_fma_f32 v[92:93], v[94:95], s[30:31], v[90:91]
    v_pk_fma_f32 v[108:109], v[94:95], s[30:31], v[90:91] neg_lo:[1,0,0] neg_hi:[1,0,0]
    v_pk_fma_f32 v[86:87], v[110:111], s[30:31], v[96:97] neg_lo:[1,0,0] neg_hi:[1,0,0]
    v_pk_fma_f32 v[88:89], v[110:111], s[30:31], v[96:97]
    v_pk_mul_f32 v[116:117], v[92:93], v[34:35] op_sel_hi:[1,0]
    v_pk_mul_f32 v[118:119], v[126:127], v[36:37] op_sel_hi:[1,0]
    v_pk_mul_f32 v[120:121], v[86:87], v[38:39] op_sel_hi:[1,0]
    v_pk_mul_f32 v[122:123], v[128:129], v[40:41] op_sel_hi:[1,0]
    v_pk_mul_f32 v[100:101], v[108:109], v[42:43] op_sel_hi:[1,0]
    v_pk_mul_f32 v[102:103], v[130:131], v[44:45] op_sel_hi:[1,0]
    v_pk_mul_f32 v[104:105], v[88:89], v[46:47] op_sel_hi:[1,0]
    v_fma_f32 v116, -v93, v35, v116
    v_fma_f32 v117, v92, v35, v117
    v_fma_f32 v118, -v127, v37, v118
    v_fma_f32 v119, v126, v37, v119
    v_fma_f32 v120, -v87, v39, v120
    v_fma_f32 v121, v86, v39, v121
    v_fma_f32 v122, -v129, v41, v122
    v_fma_f32 v123, v128, v41, v123
    v_fma_f32 v100, -v109, v43, v100
    v_fma_f32 v101, v108, v43, v101
    v_fma_f32 v102, -v131, v45, v102
    v_fma_f32 v103, v130, v45, v103
    v_fma_f32 v104, -v89, v47, v104
    v_fma_f32 v105, v88, v47, v105
    ds_write_b64 v68, v[124:125] offset:0
    ds_write_b64 v68, v[116:117] offset:288
    ds_write_b64 v68, v[118:119] offset:576
    ds_write_b64 v68, v[120:121] offset:864
    ds_write_b64 v68, v[122:123] offset:1152
    ds_write_b64 v68, v[100:101] offset:1440
    ds_write_b64 v68, v[102:103] offset:1728
    ds_write_b64 v68, v[104:105] offset:2016
    s_waitcnt lgkmcnt(0)
    ds_read_b64 v[124:125], v69 offset:0
    ds_read_b64 v[116:117], v69 offset:32
    ds_read_b64 v[118:119], v69 offset:64
    ds_read_b64 v[120:121], v69 offset:96
    ds_read_b64 v[122:123], v69 offset:128
    ds_read_b64 v[100:101], v69 offset:160
    ds_read_b64 v[102:103], v69 offset:192
    ds_read_b64 v[104:105], v69 offset:224
    s_waitcnt lgkmcnt(0)
    v_sub_f32 v112, v121, v105
    v_sub_f32 v113, v120, v104
    v_sub_f32 v98, v119, v103
    v_sub_f32 v99, v118, v102
    v_pk_add_f32 v[106:107], v[124:125], v[122:123]
    v_pk_add_f32 v[84:85], v[116:117], v[100:101]
    v_pk_add_f32 v[90:91], v[118:119], v[102:103]
    v_pk_add_f32 v[96:97], v[120:121], v[104:105]
    v_pk_add_f32 v[100:101], v[116:117], v[100:101] neg_lo:[0,1] neg_hi:[0,1]
    v_pk_add_f32 v[122:123], v[124:125], v[122:123] neg_lo:[0,1] neg_hi:[0,1]
    v_sub_f32 v124, v85, v97
    v_sub_f32 v125, v84, v96
    v_pk_add_f32 v[116:117], v[100:101], v[112:113] neg_hi:[0,1]
    v_pk_add_f32 v[118:119], v[100:101], v[112:113] neg_lo:[0,1]
    v_pk_add_f32 v[104:105], v[106:107], v[90:91]
    v_pk_add_f32 v[114:115], v[106:107], v[90:91] neg_lo:[0,1] neg_hi:[0,1]
    v_pk_add_f32 v[94:95], v[84:85], v[96:97]
    v_add_f32 v100, v116, v117
    v_sub_f32 v101, v117, v116
    v_sub_f32 v112, v118, v119
    v_add_f32 v113, v119, v118
    v_pk_add_f32 v[120:121], v[122:123], v[98:99] neg_hi:[0,1]
    v_pk_add_f32 v[102:103], v[122:123], v[98:99] neg_lo:[0,1]
    v_pk_add_f32 v[106:107], v[104:105], v[94:95]
    v_pk_add_f32 v[90:91], v[104:105], v[94:95] neg_lo:[0,1] neg_hi:[0,1]
    v_pk_add_f32 v[84:85], v[114:115], v[124:125] neg_hi:[0,1]
    v_pk_add_f32 v[96:97], v[114:115], v[124:125] neg_lo:[0,1]
    v_pk_fma_f32 v[122:123], v[100:101], s[30:31], v[120:121]
    v_pk_fma_f32 v[98:99], v[100:101], s[30:31], v[120:121] neg_lo:[1,0,0] neg_hi:[1,0,0]
    v_pk_fma_f32 v[116:117], v[112:113], s[30:31], v[102:103] neg_lo:[1,0,0] neg_hi:[1,0,0]
    v_pk_fma_f32 v[118:119], v[112:113], s[30:31], v[102:103]
    v_pk_mul_f32 v[110:111], v[122:123], v[48:49] op_sel_hi:[1,0]
    v_pk_mul_f32 v[92:93], v[84:85], v[50:51] op_sel_hi:[1,0]
    v_pk_mul_f32 v[126:127], v[116:117], v[52:53] op_sel_hi:[1,0]
    v_pk_mul_f32 v[86:87], v[90:91], v[54:55] op_sel_hi:[1,0]
    v_pk_mul_f32 v[128:129], v[98:99], v[56:57] op_sel_hi:[1,0]
    v_pk_mul_f32 v[108:109], v[96:97], v[58:59] op_sel_hi:[1,0]
    v_pk_mul_f32 v[130:131], v[118:119], v[60:61] op_sel_hi:[1,0]
    v_fma_f32 v110, -v123, v49, v110
    v_fma_f32 v111, v122, v49, v111
    v_fma_f32 v92, -v85, v51, v92
    v_fma_f32 v93, v84, v51, v93
    v_fma_f32 v126, -v117, v53, v126
    v_fma_f32 v127, v116, v53, v127
    v_fma_f32 v86, -v91, v55, v86
    v_fma_f32 v87, v90, v55, v87
    v_fma_f32 v128, -v99, v57, v128
    v_fma_f32 v129, v98, v57, v129
    v_fma_f32 v108, -v97, v59, v108
    v_fma_f32 v109, v96, v59, v109
    v_fma_f32 v130, -v119, v61, v130
    v_fma_f32 v131, v118, v61, v131
    ds_write_b64 v68, v[106:107] offset:0
    ds_write_b64 v68, v[110:111] offset:264
    ds_write_b64 v68, v[92:93] offset:528
    ds_write_b64 v68, v[126:127] offset:792
    ds_write_b64 v68, v[86:87] offset:1056
    ds_write_b64 v68, v[128:129] offset:1320
    ds_write_b64 v68, v[108:109] offset:1584
    ds_write_b64 v68, v[130:131] offset:1848
    s_waitcnt lgkmcnt(0)
    ds_read_b64 v[106:107], v71 offset:0
    ds_read_b64 v[110:111], v71 offset:8
    ds_read_b64 v[92:93], v71 offset:16
    ds_read_b64 v[126:127], v71 offset:24
    ds_read_b64 v[86:87], v71 offset:1056
    ds_read_b64 v[128:129], v71 offset:1064
    ds_read_b64 v[108:109], v71 offset:1072
    ds_read_b64 v[130:131], v71 offset:1080
    s_waitcnt lgkmcnt(0)
    v_sub_f32 v102, v111, v127
    v_sub_f32 v103, v110, v126
    v_sub_f32 v100, v129, v131
    v_sub_f32 v101, v128, v130
    v_pk_add_f32 v[88:89], v[106:107], v[92:93]
    v_pk_add_f32 v[104:105], v[86:87], v[108:109]
    v_pk_add_f32 v[124:125], v[106:107], v[92:93] neg_lo:[0,1] neg_hi:[0,1]
    v_pk_add_f32 v[114:115], v[86:87], v[108:109] neg_lo:[0,1] neg_hi:[0,1]
    v_pk_add_f32 v[120:121], v[110:111], v[126:127]
    v_pk_add_f32 v[94:95], v[128:129], v[130:131]
    v_pk_add_f32 v[110:111], v[124:125], v[102:103] neg_hi:[0,1]
    v_pk_add_f32 v[128:129], v[114:115], v[100:101] neg_hi:[0,1]
    v_pk_add_f32 v[126:127], v[124:125], v[102:103] neg_lo:[0,1]
    v_pk_add_f32 v[130:131], v[114:115], v[100:101] neg_lo:[0,1]
    v_pk_add_f32 v[106:107], v[88:89], v[120:121]
    v_pk_add_f32 v[86:87], v[104:105], v[94:95]
    v_pk_add_f32 v[92:93], v[88:89], v[120:121] neg_lo:[0,1] neg_hi:[0,1]
    v_pk_add_f32 v[108:109], v[104:105], v[94:95] neg_lo:[0,1] neg_hi:[0,1]
    ds_write_b64 v68, v[106:107] offset:0
    ds_write_b64 v68, v[110:111] offset:512
    ds_write_b64 v68, v[92:93] offset:1024
    ds_write_b64 v68, v[126:127] offset:1536
    ds_write_b64 v68, v[86:87] offset:256
    ds_write_b64 v68, v[128:129] offset:768
    ds_write_b64 v68, v[108:109] offset:1280
    ds_write_b64 v68, v[130:131] offset:1792
    buffer_store_dwordx4 v[24:27], v20, s[24:27], s45 offen sc1
    buffer_store_dwordx4 v[28:31], v20, s[24:27], s46 offen sc1
    s_waitcnt lgkmcnt(0)
    s_barrier
    ds_read_b64 v[84:85], v73 offset:0
    ds_read_b64 v[92:93], v74 offset:0
    ds_read_b64 v[86:87], v73 offset:2320
    ds_read_b64 v[94:95], v74 offset:2320
    ds_read_b64 v[88:89], v73 offset:4640
    ds_read_b64 v[96:97], v74 offset:4640
    ds_read_b64 v[90:91], v73 offset:6960
    ds_read_b64 v[98:99], v74 offset:6960
    ds_read_b64 v[124:125], v73 offset:1024
    ds_read_b64 v[126:127], v73 offset:3344
    ds_read_b64 v[128:129], v73 offset:5664
    ds_read_b64 v[130:131], v73 offset:7984
    s_waitcnt lgkmcnt(4)
    v_pk_add_f32 v[116:117], v[84:85], v[92:93] neg_hi:[0,1]
    v_pk_add_f32 v[84:85], v[84:85], v[92:93] neg_lo:[0,1]
    v_pk_add_f32 v[118:119], v[86:87], v[94:95] neg_hi:[0,1]
    v_pk_add_f32 v[86:87], v[86:87], v[94:95] neg_lo:[0,1]
    v_pk_add_f32 v[120:121], v[88:89], v[96:97] neg_hi:[0,1]
    v_pk_add_f32 v[88:89], v[88:89], v[96:97] neg_lo:[0,1]
    v_pk_add_f32 v[122:123], v[90:91], v[98:99] neg_hi:[0,1]
    v_pk_add_f32 v[90:91], v[90:91], v[98:99] neg_lo:[0,1]
    v_pk_mul_f32 v[92:93], v[84:85], v[16:17] op_sel_hi:[1,0]
    v_pk_mul_f32 v[94:95], v[86:87], v[16:17] op_sel_hi:[1,0]
    v_pk_mul_f32 v[96:97], v[88:89], v[16:17] op_sel_hi:[1,0]
    v_pk_mul_f32 v[98:99], v[90:91], v[16:17] op_sel_hi:[1,0]
    v_fma_f32 v92, -v85, v17, v92
    v_fma_f32 v93, v84, v17, v93
    v_fma_f32 v94, -v87, v17, v94
    v_fma_f32 v95, v86, v17, v95
    v_fma_f32 v96, -v89, v17, v96
    v_fma_f32 v97, v88, v17, v97
    v_fma_f32 v98, -v91, v17, v98
    v_fma_f32 v99, v90, v17, v99
    v_pk_fma_f32 v[100:101], v[116:117], s[32:33], v[92:93]
    v_pk_fma_f32 v[108:109], v[116:117], s[32:33], v[92:93] neg_lo:[0,0,1] neg_hi:[1,0,0]
    v_pk_fma_f32 v[102:103], v[118:119], s[32:33], v[94:95]
    v_pk_fma_f32 v[110:111], v[118:119], s[32:33], v[94:95] neg_lo:[0,0,1] neg_hi:[1,0,0]
    v_pk_fma_f32 v[104:105], v[120:121], s[32:33], v[96:97]
    v_pk_fma_f32 v[112:113], v[120:121], s[32:33], v[96:97] neg_lo:[0,0,1] neg_hi:[1,0,0]
    v_pk_fma_f32 v[106:107], v[122:123], s[32:33], v[98:99]
    v_pk_fma_f32 v[114:115], v[122:123], s[32:33], v[98:99] neg_lo:[0,0,1] neg_hi:[1,0,0]
    s_waitcnt lgkmcnt(0)
    v_cmp_gt_u32 vcc, 4, v0
    s_nop 0
    s_and_saveexec_b64 s[48:49], vcc
    v_mov_b32 v101, v108
    v_mov_b32 v108, v124
    v_xor_b32 v109, 0x80000000, v125
    v_mov_b32 v103, v110
    v_mov_b32 v110, v126
    v_xor_b32 v111, 0x80000000, v127
    v_mov_b32 v105, v112
    v_mov_b32 v112, v128
    v_xor_b32 v113, 0x80000000, v129
    v_mov_b32 v107, v114
    v_mov_b32 v114, v130
    v_xor_b32 v115, 0x80000000, v131
    s_mov_b64 exec, s[48:49]
    v_cvt_f16_f32 v100, v100
    v_cvt_f16_f32 v101, v101
    v_cvt_f16_f32 v102, v102
    v_cvt_f16_f32 v103, v103
    v_cvt_f16_f32 v104, v104
    v_cvt_f16_f32 v105, v105
    v_cvt_f16_f32 v106, v106
    v_cvt_f16_f32 v107, v107
    v_cvt_f16_f32 v108, v108
    v_cvt_f16_f32 v109, v109
    v_cvt_f16_f32 v110, v110
    v_cvt_f16_f32 v111, v111
    v_cvt_f16_f32 v112, v112
    v_cvt_f16_f32 v113, v113
    v_cvt_f16_f32 v114, v114
    v_cvt_f16_f32 v115, v115
    v_pack_b32_f16 v84, v100, v101
    v_pack_b32_f16 v88, v108, v109
    v_pack_b32_f16 v85, v102, v103
    v_pack_b32_f16 v89, v110, v111
    v_pack_b32_f16 v86, v104, v105
    v_pack_b32_f16 v90, v112, v113
    v_pack_b32_f16 v87, v106, v107
    v_pack_b32_f16 v91, v114, v115
    buffer_store_dwordx4 v[84:87], v79, s[24:27], s44 offen sc1
    buffer_store_dwordx4 v[88:91], v80, s[24:27], s44 offen sc1
    s_endpgm
L0_aux:
    s_sub_u32 s40, s2, 128
    s_load_dwordx2 s[6:7], s[0:1], 8
    s_load_dwordx2 s[8:9], s[0:1], 16
    s_load_dwordx2 s[10:11], s[0:1], 72
    s_load_dwordx4 s[52:55], s[0:1], 32
    s_load_dwordx2 s[56:57], s[0:1], 48
    s_lshr_b32 s41, s40, 1
    s_and_b32 s42, s40, 1
    v_lshrrev_b32 v1, 7, v0
    s_nop 0
    v_readfirstlane_b32 s43, v1
    s_lshl_b32 s50, s41, 2
    s_add_u32 s50, s50, s43
    s_lshr_b32 s28, s50, 5
    s_bfe_u32 s29, s50, 0x30002
    s_lshl_b32 s29, s29, 3
    s_add_u32 s28, s28, s29
    s_and_b32 s29, s50, 3
    s_lshl_b32 s29, s29, 6
    s_add_u32 s28, s28, s29
    s_mul_i32 s28, s28, 514
    s_lshl_b32 s29, s42, 8
    s_add_u32 s28, s28, s29
    s_add_u32 s32, s28, 0
    s_add_u32 s33, s28, 263168
    s_add_u32 s34, s28, 526336
    s_add_u32 s35, s28, 789504
    s_add_u32 s36, s28, 131584
    s_add_u32 s37, s28, 394752
    s_add_u32 s38, s28, 657920
    s_add_u32 s39, s28, 921088
    v_and_b32 v5, 127, v0
    v_lshlrev_b32 v4, 1, v5
    v_and_b32 v2, 7, v5
    s_lshl_b32 s29, s43, 1
    v_xor_b32 v3, s29, v2
    v_lshlrev_b32 v10, 7, v5
    v_lshl_add_u32 v10, v3, 4, v10
    v_xor_b32 v11, 16, v10
    v_lshlrev_b32 v12, 4, v0
    v_lshrrev_b32 v2, 3, v0
    v_xor_b32 v3, v2, v0
    v_and_b32 v3, 7, v3
    v_lshlrev_b32 v6, 13, v2
    v_lshl_add_u32 v6, v3, 4, v6
    s_lshl_b32 s50, s42, 20
    s_lshl_b32 s51, s41, 7
    s_add_u32 s50, s50, s51
    s_add_u32 s50, s50, 6291456
    s_add_u32 s51, s50, 524288
    v_bfe_u32 v7, v0, 3, 2
    s_lshl_b32 s43, s41, 2
    v_add_u32 v7, s43, v7
    v_lshrrev_b32 v8, 5, v7
    v_bfe_u32 v9, v7, 2, 3
    v_lshl_add_u32 v8, v9, 3, v8
    v_and_b32 v9, 3, v7
    v_lshl_add_u32 v8, v9, 6, v8
    v_bfe_u32 v9, v0, 2, 1
    v_lshl_add_u32 v8, v9, 8, v8
    v_and_b32 v9, 3, v0
    v_lshl_add_u32 v8, v9, 9, v8
    v_mul_u32_u24 v8, 514, v8
    v_add_u32 v8, 512, v8
    v_and_b32 v9, 31, v0
    v_lshlrev_b32 v9, 2, v9
    s_lshl_b32 s43, s41, 7
    s_add_u32 s43, s43, 8388608
    v_lshrrev_b32 v72, 1, v0
    s_lshl_b32 s58, s40, 8
    v_add_u32 v72, s58, v72
    v_and_b32 v63, 15, v72
    v_lshrrev_b32 v64, 10, v72
    v_lshl_add_u32 v63, v64, 4, v63
    v_bfe_u32 v64, v72, 4, 6
    v_lshlrev_b32 v64, 2, v64
    v_and_b32 v65, 1, v0
    v_lshl_add_u32 v64, v65, 1, v64
    v_lshlrev_b32 v72, 4, v72
    v_lshl_add_u32 v72, v65, 3, v72
    v_mul_u32_u24 v65, v64, v63
    v_add_u32 v66, v65, v63
    v_and_b32 v65, 511, v65
    v_and_b32 v66, 511, v66
    v_cvt_f32_u32 v65, v65
    v_cvt_f32_u32 v66, v66
    v_mul_f32 v65, 0x3b000000, v65
    v_mul_f32 v66, 0x3b000000, v66
    v_cos_f32 v68, v65
    v_sin_f32 v69, -v65
    v_cos_f32 v70, v66
    v_sin_f32 v71, -v66
    v_and_b32 v65, 1, v63
    v_lshlrev_b32 v65, 31, v65
    v_or_b32 v65, 0.5, v65
    v_mov_b32 v66, 0.5
    v_cmp_eq_u32 vcc, 0, v64
    s_nop 1
    v_cndmask_b32 v68, v68, v66, vcc
    v_cndmask_b32 v69, v69, v65, vcc
    s_mov_b32 s58, 0x36000000
    v_mul_f32 v68, s58, v68
    v_mul_f32 v69, s58, v69
    v_mul_f32 v70, s58, v70
    v_mul_f32 v71, s58, v71
    v_cvt_pk_bf16_f32 v68, v68, v69
    v_cvt_pk_bf16_f32 v69, v70, v71
    s_waitcnt lgkmcnt(0)
    s_mov_b32 s16, s6
    s_and_b32 s17, s7, 0xffff
    s_mov_b32 s18, 0x101000
    s_mov_b32 s19, 0x00020000
    s_mov_b32 s20, s8
    s_and_b32 s21, s9, 0xffff
    s_mov_b32 s22, 0x101000
    s_mov_b32 s23, 0x00020000
    s_mov_b32 s24, s10
    s_and_b32 s25, s11, 0xffff
    s_mov_b32 s26, 0x10000000
    s_mov_b32 s27, 0x00020000
    buffer_load_ushort v16, v4, s[16:19], s32 offen
    buffer_load_ushort v24, v4, s[20:23], s32 offen
    buffer_load_ushort v17, v4, s[16:19], s33 offen
    buffer_load_ushort v25, v4, s[20:23], s33 offen
    buffer_load_ushort v18, v4, s[16:19], s34 offen
    buffer_load_ushort v26, v4, s[20:23], s34 offen
    buffer_load_ushort v19, v4, s[16:19], s35 offen
    buffer_load_ushort v27, v4, s[20:23], s35 offen
    buffer_load_ushort v20, v4, s[16:19], s36 offen
    buffer_load_ushort v28, v4, s[20:23], s36 offen
    buffer_load_ushort v21, v4, s[16:19], s37 offen
    buffer_load_ushort v29, v4, s[20:23], s37 offen
    buffer_load_ushort v22, v4, s[16:19], s38 offen
    buffer_load_ushort v30, v4, s[20:23], s38 offen
    buffer_load_ushort v23, v4, s[16:19], s39 offen
    buffer_load_ushort v31, v4, s[20:23], s39 offen
    buffer_load_ushort v32, v8, s[16:19], 0 offen
    buffer_load_ushort v33, v8, s[20:23], 0 offen
    s_mov_b32 s60, s54
    s_and_b32 s61, s55, 0xffff
    s_mov_b32 s62, 0x1c0000
    s_mov_b32 s63, 0x00020000
    v_bfe_u32 v62, v0, 4, 5
    v_and_b32 v63, 7, v0
    v_min_u32 v63, 6, v63
    v_mul_u32_u24 v62, 3584, v62
    v_lshl_add_u32 v62, v63, 7, v62
    s_lshr_b32 s58, s40, 3
    s_mul_i32 s58, s58, 114688
    s_bfe_u32 s59, s40, 0x20001
    s_mul_i32 s59, s59, 896
    s_add_u32 s58, s58, s59
    v_mov_b32 v82, v62
    s_mov_b32 s30, s58
    s_getpc_b64 s[68:69]
L0_pc:
    s_add_u32 s68, s68, l1_kernel-L0_pc
    s_addc_u32 s69, s69, 0
    s_lshr_b32 s58, s40, 3
    s_lshl_b32 s58, s58, 12
    v_and_b32 v62, 31, v0
    v_lshlrev_b32 v62, 7, v62
    v_add_u32 v62, s58, v62
    v_min_u32 v62, CODE_BYTES-4, v62
    global_load_dword v84, v62, s[68:69]
    s_mov_b32 s58, 19922944
    buffer_store_dwordx2 v[68:69], v72, s[24:27], s58 offen sc1
    s_waitcnt vmcnt(2)
    v_lshl_or_b32 v16, v24, 16, v16
    v_lshl_or_b32 v17, v25, 16, v17
    v_lshl_or_b32 v18, v26, 16, v18
    v_lshl_or_b32 v19, v27, 16, v19
    v_lshl_or_b32 v20, v28, 16, v20
    v_lshl_or_b32 v21, v29, 16, v21
    v_lshl_or_b32 v22, v30, 16, v22
    v_lshl_or_b32 v23, v31, 16, v23
    ds_write_b128 v10, v[16:19]
    ds_write_b128 v11, v[20:23]
    s_waitcnt lgkmcnt(0)
    s_barrier
    ds_read_b128 v[16:19], v12
    ds_read_b128 v[20:23], v12 offset:8192
    s_waitcnt lgkmcnt(0)
    buffer_store_dwordx4 v[16:19], v6, s[24:27], s50 offen sc1
    buffer_store_dwordx4 v[20:23], v6, s[24:27], s51 offen sc1
    v_cmp_le_u32 vcc, 256, v0
    s_cbranch_vccz L0_noup2
    buffer_load_dword v83, v82, s[60:63], s30 offen
L0_noup2:
    v_lshl_or_b32 v32, v33, 16, v32
    s_cmp_eq_u32 s42, 0
    s_cbranch_scc1 L0_skipw
    v_cmp_gt_u32 vcc, 32, v0
    s_nop 0
    s_and_saveexec_b64 s[48:49], vcc
    s_cbranch_execz L0_skipw2
    buffer_store_dword v32, v9, s[24:27], s43 offen sc1
L0_skipw2:
    s_mov_b64 exec, s[48:49]
L0_skipw:
    s_endpgm
L0_end:
    s_endpgm

.section .rodata,"a"
.p2align 6
.amdhsa_kernel l0_kernel
  .amdhsa_next_free_vgpr 136
  .amdhsa_next_free_sgpr 96
  .amdhsa_accum_offset 136
  .amdhsa_group_segment_fixed_size 0
  .amdhsa_kernarg_size 80
  .amdhsa_user_sgpr_count 2
  .amdhsa_user_sgpr_kernarg_segment_ptr 1
  .amdhsa_system_sgpr_workgroup_id_x 1
  .amdhsa_float_denorm_mode_32 3
.end_amdhsa_kernel
.text
.globl l1_kernel
.p2align 8
.type l1_kernel,@function
l1_kernel:
    s_cmp_ge_u32 s2, 481
    s_cbranch_scc1 L1_end
    s_setprio 2
    s_load_dwordx2 s[10:11], s[0:1], 72
    s_load_dwordx4 s[4:7], s[0:1], 32
    s_load_dwordx2 s[8:9], s[0:1], 48
    s_cmp_lt_u32 s2, 224
    s_cbranch_scc1 L1_gemm
    s_waitcnt lgkmcnt(0)
    s_mov_b32 s24, s10
    s_and_b32 s25, s11, 0xffff
    s_mov_b32 s26, 0x10000000
    s_mov_b32 s27, 0x00020000
    s_mov_b32 s20, s8
    s_and_b32 s21, s9, 0xffff
    s_mov_b32 s22, 0x1c0000
    s_mov_b32 s23, 0x00020000
    s_mov_b32 s12, s4
    s_and_b32 s13, s5, 0xffff
    s_mov_b32 s14, 0x1c0000
    s_mov_b32 s15, 0x00020000
    s_mov_b32 s16, s6
    s_and_b32 s17, s7, 0xffff
    s_mov_b32 s18, 0x1c0000
    s_mov_b32 s19, 0x00020000
    s_setprio 2
    s_sub_u32 s40, s2, 224
    s_and_b32 s41, s40, 7
    s_lshl_b32 s41, s41, 5
    s_lshr_b32 s42, s40, 3
    s_add_u32 s41, s41, s42
    s_cmp_eq_u32 s40, 256
    s_cselect_b32 s40, 256, s41
    s_and_b32 s41, s40, 255
    s_lshl_b32 s42, s41, 6
    s_add_u32 s42, s42, 2097152
    v_lshrrev_b32 v3, 4, v0
    v_lshlrev_b32 v3, 14, v3
    v_and_b32 v4, 15, v0
    v_lshl_add_u32 v3, v4, 2, v3
    s_lshl_b32 s46, s40, 13
    s_add_u32 s46, s46, 6291456
    v_lshlrev_b32 v1, 3, v0
    v_lshlrev_b32 v2, 5, v0
    buffer_load_dword v85, v3, s[24:27], s42 offen
    s_add_u32 s42, s42, 262144
    buffer_load_dword v87, v3, s[24:27], s42 offen
    s_add_u32 s42, s42, 262144
    buffer_load_dword v89, v3, s[24:27], s42 offen
    s_add_u32 s42, s42, 262144
    buffer_load_dword v91, v3, s[24:27], s42 offen
    s_add_u32 s42, s42, 262144
    buffer_load_dword v93, v3, s[24:27], s42 offen
    s_add_u32 s42, s42, 262144
    buffer_load_dword v95, v3, s[24:27], s42 offen
    s_add_u32 s42, s42, 262144
    buffer_load_dword v97, v3, s[24:27], s42 offen
    s_add_u32 s42, s42, 262144
    buffer_load_dword v99, v3, s[24:27], s42 offen
    buffer_load_dwordx4 v[8:11], v2, s[24:27], s46 offen
    buffer_load_dwordx4 v[12:15], v2, s[24:27], s46 offen offset:16
    v_min_u32 v16, 55, v0
    v_lshlrev_b32 v16, 7, v16
    s_mul_i32 s47, s41, 7168
    buffer_load_dword v17, v16, s[20:23], s47 offen
    s_mov_b32 s30, 0x3f3504f3
    s_mov_b32 s31, 0x3f3504f3
    v_and_b32 v3, 31, v0
    v_lshrrev_b32 v4, 5, v0
    v_cvt_f32_u32 v62, v0
    v_mul_f32 v62, 0x3a000000, v62
    v_mul_f32 v21, 1.0, v62
    v_mul_f32 v23, 2.0, v62
    v_mul_f32 v25, 0x40400000, v62
    v_mul_f32 v27, 4.0, v62
    v_mul_f32 v29, 0x40a00000, v62
    v_mul_f32 v31, 0x40c00000, v62
    v_mul_f32 v33, 0x40e00000, v62
    v_cos_f32 v20, v21
    v_sin_f32 v21, -v21
    v_cos_f32 v22, v23
    v_sin_f32 v23, -v23
    v_cos_f32 v24, v25
    v_sin_f32 v25, -v25
    v_cos_f32 v26, v27
    v_sin_f32 v27, -v27
    v_cos_f32 v28, v29
    v_sin_f32 v29, -v29
    v_cos_f32 v30, v31
    v_sin_f32 v31, -v31
    v_cos_f32 v32, v33
    v_sin_f32 v33, -v33
    v_cvt_f32_u32 v62, v3
    v_mul_f32 v62, 0x3b800000, v62
    v_mul_f32 v35, 1.0, v62
    v_mul_f32 v37, 2.0, v62
    v_mul_f32 v39, 0x40400000, v62
    v_mul_f32 v41, 4.0, v62
    v_mul_f32 v43, 0x40a00000, v62
    v_mul_f32 v45, 0x40c00000, v62
    v_mul_f32 v47, 0x40e00000, v62
    v_cos_f32 v34, v35
    v_sin_f32 v35, -v35
    v_cos_f32 v36, v37
    v_sin_f32 v37, -v37
    v_cos_f32 v38, v39
    v_sin_f32 v39, -v39
    v_cos_f32 v40, v41
    v_sin_f32 v41, -v41
    v_cos_f32 v42, v43
    v_sin_f32 v43, -v43
    v_cos_f32 v44, v45
    v_sin_f32 v45, -v45
    v_cos_f32 v46, v47
    v_sin_f32 v47, -v47
    v_and_b32 v62, 3, v3
    v_cvt_f32_u32 v62, v62
    v_mul_f32 v62, 0x3d000000, v62
    v_mul_f32 v49, 1.0, v62
    v_mul_f32 v51, 2.0, v62
    v_mul_f32 v53, 0x40400000, v62
    v_mul_f32 v55, 4.0, v62
    v_mul_f32 v57, 0x40a00000, v62
    v_mul_f32 v59, 0x40c00000, v62
    v_mul_f32 v61, 0x40e00000, v62
    v_cos_f32 v48, v49
    v_sin_f32 v49, -v49
    v_cos_f32 v50, v51
    v_sin_f32 v51, -v51
    v_cos_f32 v52, v53
    v_sin_f32 v53, -v53
    v_cos_f32 v54, v55
    v_sin_f32 v55, -v55
    v_cos_f32 v56, v57
    v_sin_f32 v57, -v57
    v_cos_f32 v58, v59
    v_sin_f32 v59, -v59
    v_cos_f32 v60, v61
    v_sin_f32 v61, -v61
    v_mul_u32_u24 v75, 2304, v4
    v_lshl_add_u32 v68, v3, 3, v75
    v_mov_b32 v70, v68
    v_lshrrev_b32 v76, 2, v3
    v_and_b32 v77, 3, v3
    v_mul_u32_u24 v78, 288, v76
    v_lshl_add_u32 v78, v77, 3, v78
    v_add_u32 v69, v78, v75
    v_mul_u32_u24 v78, 264, v77
    v_lshl_add_u32 v78, v76, 5, v78
    v_add_u32 v71, v78, v75
    s_waitcnt vmcnt(3)
    s_setprio 1
    v_cvt_f32_f16 v84, v85
    v_cvt_f32_f16_sdwa v85, v85 dst_sel:DWORD dst_unused:UNUSED_PAD src0_sel:WORD_1
    v_cvt_f32_f16 v86, v87
    v_cvt_f32_f16_sdwa v87, v87 dst_sel:DWORD dst_unused:UNUSED_PAD src0_sel:WORD_1
    v_cvt_f32_f16 v88, v89
    v_cvt_f32_f16_sdwa v89, v89 dst_sel:DWORD dst_unused:UNUSED_PAD src0_sel:WORD_1
    v_cvt_f32_f16 v90, v91
    v_cvt_f32_f16_sdwa v91, v91 dst_sel:DWORD dst_unused:UNUSED_PAD src0_sel:WORD_1
    v_cvt_f32_f16 v92, v93
    v_cvt_f32_f16_sdwa v93, v93 dst_sel:DWORD dst_unused:UNUSED_PAD src0_sel:WORD_1
    v_cvt_f32_f16 v94, v95
    v_cvt_f32_f16_sdwa v95, v95 dst_sel:DWORD dst_unused:UNUSED_PAD src0_sel:WORD_1
    v_cvt_f32_f16 v96, v97
    v_cvt_f32_f16_sdwa v97, v97 dst_sel:DWORD dst_unused:UNUSED_PAD src0_sel:WORD_1
    v_cvt_f32_f16 v98, v99
    v_cvt_f32_f16_sdwa v99, v99 dst_sel:DWORD dst_unused:UNUSED_PAD src0_sel:WORD_1
    s_cmp_lg_u32 s41, 0
    s_cbranch_scc1 L1_fft_go
    s_cmp_eq_u32 s40, 0
    s_cbranch_scc1 L1_fft_zero
    v_mov_b32 v84, v85
    v_mov_b32 v86, v87
    v_mov_b32 v88, v89
    v_mov_b32 v90, v91
    v_mov_b32 v92, v93
    v_mov_b32 v94, v95
    v_mov_b32 v96, v97
    v_mov_b32 v98, v99
L1_fft_zero:
    v_mov_b32 v85, 0
    v_mov_b32 v87, 0
    v_mov_b32 v89, 0
    v_mov_b32 v91, 0
    v_mov_b32 v93, 0
    v_mov_b32 v95, 0
    v_mov_b32 v97, 0
    v_mov_b32 v99, 0
L1_fft_go:
    v_sub_f32 v110, v91, v99
    v_sub_f32 v111, v90, v98
    v_sub_f32 v108, v89, v97
    v_sub_f32 v109, v88, v96
    v_add_f32 v100, v84, v92
    v_add_f32 v101, v85, v93
    v_add_f32 v102, v86, v94
    v_add_f32 v103, v87, v95
    v_add_f32 v104, v88, v96
    v_add_f32 v105, v89, v97
    v_add_f32 v106, v90, v98
    v_add_f32 v107, v91, v99
    v_sub_f32 v94, v86, v94
    v_sub_f32 v95, v87, v95
    v_sub_f32 v92, v84, v92
    v_sub_f32 v93, v85, v93
    v_sub_f32 v84, v103, v107
    v_sub_f32 v85, v102, v106
    v_add_f32 v86, v94, v110
    v_sub_f32 v87, v95, v111
    v_sub_f32 v88, v94, v110
    v_add_f32 v89, v95, v111
    v_add_f32 v98, v100, v104
    v_add_f32 v99, v101, v105
    v_sub_f32 v112, v100, v104
    v_sub_f32 v113, v101, v105
    v_add_f32 v114, v102, v106
    v_add_f32 v115, v103, v107
    v_add_f32 v94, v86, v87
    v_sub_f32 v95, v87, v86
    v_sub_f32 v110, v88, v89
    v_add_f32 v111, v89, v88
    v_add_f32 v90, v92, v108
    v_sub_f32 v91, v93, v109
    v_sub_f32 v96, v92, v108
    v_add_f32 v97, v93, v109
    v_add_f32 v100, v98, v114
    v_add_f32 v101, v99, v115
    v_sub_f32 v104, v98, v114
    v_sub_f32 v105, v99, v115
    v_add_f32 v102, v112, v84
    v_sub_f32 v103, v113, v85
    v_sub_f32 v106, v112, v84
    v_add_f32 v107, v113, v85
    v_fma_f32 v92, v94, s30, v90
    v_fma_f32 v93, v95, s30, v91
    v_fma_f32 v108, -v94, s30, v90
    v_fma_f32 v109, -v95, s30, v91
    v_fma_f32 v86, -v110, s30, v96
    v_fma_f32 v87, -v111, s30, v97
    v_fma_f32 v88, v110, s30, v96
    v_fma_f32 v89, v111, s30, v97
    v_mul_f32 v116, v92, v20
    v_mul_f32 v117, v93, v20
    v_mul_f32 v118, v102, v22
    v_mul_f32 v119, v103, v22
    v_mul_f32 v120, v86, v24
    v_mul_f32 v121, v87, v24
    v_mul_f32 v122, v104, v26
    v_mul_f32 v123, v105, v26
    v_mul_f32 v124, v108, v28
    v_mul_f32 v125, v109, v28
    v_mul_f32 v126, v106, v30
    v_mul_f32 v127, v107, v30
    v_mul_f32 v128, v88, v32
    v_mul_f32 v129, v89, v32
    v_fma_f32 v116, -v93, v21, v116
    v_fma_f32 v117, v92, v21, v117
    v_fma_f32 v118, -v103, v23, v118
    v_fma_f32 v119, v102, v23, v119
    v_fma_f32 v120, -v87, v25, v120
    v_fma_f32 v121, v86, v25, v121
    v_fma_f32 v122, -v105, v27, v122
    v_fma_f32 v123, v104, v27, v123
    v_fma_f32 v124, -v109, v29, v124
    v_fma_f32 v125, v108, v29, v125
    v_fma_f32 v126, -v107, v31, v126
    v_fma_f32 v127, v106, v31, v127
    v_fma_f32 v128, -v89, v33, v128
    v_fma_f32 v129, v88, v33, v129
    ds_write_b64 v1, v[100:101] offset:0
    ds_write_b64 v1, v[116:117] offset:2304
    ds_write_b64 v1, v[118:119] offset:4608
    ds_write_b64 v1, v[120:121] offset:6912
    ds_write_b64 v1, v[122:123] offset:9216
    ds_write_b64 v1, v[124:125] offset:11520
    ds_write_b64 v1, v[126:127] offset:13824
    ds_write_b64 v1, v[128:129] offset:16128
    s_waitcnt lgkmcnt(0)
    s_barrier
    ds_read_b64 v[100:101], v68 offset:0
    ds_read_b64 v[116:117], v68 offset:256
    ds_read_b64 v[118:119], v68 offset:512
    ds_read_b64 v[120:121], v68 offset:768
    ds_read_b64 v[122:123], v68 offset:1024
    ds_read_b64 v[124:125], v68 offset:1280
    ds_read_b64 v[126:127], v68 offset:1536
    ds_read_b64 v[128:129], v68 offset:1792
    s_waitcnt lgkmcnt(0)
    v_sub_f32 v112, v121, v129
    v_sub_f32 v113, v120, v128
    v_sub_f32 v98, v119, v127
    v_sub_f32 v99, v118, v126
    v_add_f32 v130, v100, v122
    v_add_f32 v131, v101, v123
    v_add_f32 v84, v116, v124
    v_add_f32 v85, v117, v125
    v_add_f32 v90, v118, v126
    v_add_f32 v91, v119, v127
    v_add_f32 v96, v120, v128
    v_add_f32 v97, v121, v129
    v_sub_f32 v124, v116, v124
    v_sub_f32 v125, v117, v125
    v_sub_f32 v122, v100, v122
    v_sub_f32 v123, v101, v123
    v_sub_f32 v100, v85, v97
    v_sub_f32 v101, v84, v96
    v_add_f32 v116, v124, v112
    v_sub_f32 v117, v125, v113
    v_sub_f32 v118, v124, v112
    v_add_f32 v119, v125, v113
    v_add_f32 v128, v130, v90
    v_add_f32 v129, v131, v91
    v_sub_f32 v114, v130, v90
    v_sub_f32 v115, v131, v91
    v_add_f32 v94, v84, v96
    v_add_f32 v95, v85, v97
    v_add_f32 v124, v116, v117
    v_sub_f32 v125, v117, v116
    v_sub_f32 v112, v118, v119
    v_add_f32 v113, v119, v118
    v_add_f32 v120, v122, v98
    v_sub_f32 v121, v123, v99
    v_sub_f32 v126, v122, v98
    v_add_f32 v127, v123, v99
    v_add_f32 v130, v128, v94
    v_add_f32 v131, v129, v95
    v_sub_f32 v90, v128, v94
    v_sub_f32 v91, v129, v95
    v_add_f32 v84, v114, v100
    v_sub_f32 v85, v115, v101
    v_sub_f32 v96, v114, v100
    v_add_f32 v97, v115, v101
    v_fma_f32 v122, v124, s30, v120
    v_fma_f32 v123, v125, s30, v121
    v_fma_f32 v98, -v124, s30, v120
    v_fma_f32 v99, -v125, s30, v121
    v_fma_f32 v116, -v112, s30, v126
    v_fma_f32 v117, -v113, s30, v127
    v_fma_f32 v118, v112, s30, v126
    v_fma_f32 v119, v113, s30, v127
    v_mul_f32 v110, v122, v34
    v_mul_f32 v111, v123, v34
    v_mul_f32 v92, v84, v36
    v_mul_f32 v93, v85, v36
    v_mul_f32 v102, v116, v38
    v_mul_f32 v103, v117, v38
    v_mul_f32 v86, v90, v40
    v_mul_f32 v87, v91, v40
    v_mul_f32 v104, v98, v42
    v_mul_f32 v105, v99, v42
    v_mul_f32 v108, v96, v44
    v_mul_f32 v109, v97, v44
    v_mul_f32 v106, v118, v46
    v_mul_f32 v107, v119, v46
    v_fma_f32 v110, -v123, v35, v110
    v_fma_f32 v111, v122, v35, v111
    v_fma_f32 v92, -v85, v37, v92
    v_fma_f32 v93, v84, v37, v93
    v_fma_f32 v102, -v117, v39, v102
    v_fma_f32 v103, v116, v39, v103
    v_fma_f32 v86, -v91, v41, v86
    v_fma_f32 v87, v90, v41, v87
    v_fma_f32 v104, -v99, v43, v104
    v_fma_f32 v105, v98, v43, v105
    v_fma_f32 v108, -v97, v45, v108
    v_fma_f32 v109, v96, v45, v109
    v_fma_f32 v106, -v119, v47, v106
    v_fma_f32 v107, v118, v47, v107
    ds_write_b64 v68, v[130:131] offset:0
    ds_write_b64 v68, v[110:111] offset:288
    ds_write_b64 v68, v[92:93] offset:576
    ds_write_b64 v68, v[102:103] offset:864
    ds_write_b64 v68, v[86:87] offset:1152
    ds_write_b64 v68, v[104:105] offset:1440
    ds_write_b64 v68, v[108:109] offset:1728
    ds_write_b64 v68, v[106:107] offset:2016
    s_waitcnt lgkmcnt(0)
    ds_read_b64 v[130:131], v69 offset:0
    ds_read_b64 v[110:111], v69 offset:32
    ds_read_b64 v[92:93], v69 offset:64
    ds_read_b64 v[102:103], v69 offset:96
    ds_read_b64 v[86:87], v69 offset:128
    ds_read_b64 v[104:105], v69 offset:160
    ds_read_b64 v[108:109], v69 offset:192
    ds_read_b64 v[106:107], v69 offset:224
    s_waitcnt lgkmcnt(0)
    v_sub_f32 v114, v103, v107
    v_sub_f32 v115, v102, v106
    v_sub_f32 v128, v93, v109
    v_sub_f32 v129, v92, v108
    v_add_f32 v88, v130, v86
    v_add_f32 v89, v131, v87
    v_add_f32 v100, v110, v104
    v_add_f32 v101, v111, v105
    v_add_f32 v120, v92, v108
    v_add_f32 v121, v93, v109
    v_add_f32 v126, v102, v106
    v_add_f32 v127, v103, v107
    v_sub_f32 v104, v110, v104
    v_sub_f32 v105, v111, v105
    v_sub_f32 v86, v130, v86
    v_sub_f32 v87, v131, v87
    v_sub_f32 v130, v101, v127
    v_sub_f32 v131, v100, v126
    v_add_f32 v110, v104, v114
    v_sub_f32 v111, v105, v115
    v_sub_f32 v92, v104, v114
    v_add_f32 v93, v105, v115
    v_add_f32 v106, v88, v120
    v_add_f32 v107, v89, v121
    v_sub_f32 v94, v88, v120
    v_sub_f32 v95, v89, v121
    v_add_f32 v124, v100, v126
    v_add_f32 v125, v101, v127
    v_add_f32 v104, v110, v111
    v_sub_f32 v105, v111, v110
    v_sub_f32 v114, v92, v93
    v_add_f32 v115, v93, v92
    v_add_f32 v102, v86, v128
    v_sub_f32 v103, v87, v129
    v_sub_f32 v108, v86, v128
    v_add_f32 v109, v87, v129
    v_add_f32 v88, v106, v124
    v_add_f32 v89, v107, v125
    v_sub_f32 v120, v106, v124
    v_sub_f32 v121, v107, v125
    v_add_f32 v100, v94, v130
    v_sub_f32 v101, v95, v131
    v_sub_f32 v126, v94, v130
    v_add_f32 v127, v95, v131
    v_fma_f32 v86, v104, s30, v102
    v_fma_f32 v87, v105, s30, v103
    v_fma_f32 v128, -v104, s30, v102
    v_fma_f32 v129, -v105, s30, v103
    v_fma_f32 v110, -v114, s30, v108
    v_fma_f32 v111, -v115, s30, v109
    v_fma_f32 v92, v114, s30, v108
    v_fma_f32 v93, v115, s30, v109
    v_mul_f32 v112, v86, v48
    v_mul_f32 v113, v87, v48
    v_mul_f32 v122, v100, v50
    v_mul_f32 v123, v101, v50
    v_mul_f32 v84, v110, v52
    v_mul_f32 v85, v111, v52
    v_mul_f32 v116, v120, v54
    v_mul_f32 v117, v121, v54
    v_mul_f32 v90, v128, v56
    v_mul_f32 v91, v129, v56
    v_mul_f32 v98, v126, v58
    v_mul_f32 v99, v127, v58
    v_mul_f32 v96, v92, v60
    v_mul_f32 v97, v93, v60
    v_fma_f32 v112, -v87, v49, v112
    v_fma_f32 v113, v86, v49, v113
    v_fma_f32 v122, -v101, v51, v122
    v_fma_f32 v123, v100, v51, v123
    v_fma_f32 v84, -v111, v53, v84
    v_fma_f32 v85, v110, v53, v85
    v_fma_f32 v116, -v121, v55, v116
    v_fma_f32 v117, v120, v55, v117
    v_fma_f32 v90, -v129, v57, v90
    v_fma_f32 v91, v128, v57, v91
    v_fma_f32 v98, -v127, v59, v98
    v_fma_f32 v99, v126, v59, v99
    v_fma_f32 v96, -v93, v61, v96
    v_fma_f32 v97, v92, v61, v97
    ds_write_b64 v70, v[88:89] offset:0
    ds_write_b64 v70, v[112:113] offset:264
    ds_write_b64 v70, v[122:123] offset:528
    ds_write_b64 v70, v[84:85] offset:792
    ds_write_b64 v70, v[116:117] offset:1056
    ds_write_b64 v70, v[90:91] offset:1320
    ds_write_b64 v70, v[98:99] offset:1584
    ds_write_b64 v70, v[96:97] offset:1848
    s_waitcnt lgkmcnt(0)
    ds_read_b64 v[88:89], v71 offset:0
    ds_read_b64 v[112:113], v71 offset:8
    ds_read_b64 v[122:123], v71 offset:16
    ds_read_b64 v[84:85], v71 offset:24
    ds_read_b64 v[116:117], v71 offset:1056
    ds_read_b64 v[90:91], v71 offset:1064
    ds_read_b64 v[98:99], v71 offset:1072
    ds_read_b64 v[96:97], v71 offset:1080
    s_waitcnt lgkmcnt(0)
    v_sub_f32 v108, v113, v85
    v_sub_f32 v109, v112, v84
    v_sub_f32 v104, v91, v97
    v_sub_f32 v105, v90, v96
    v_add_f32 v118, v88, v122
    v_add_f32 v119, v89, v123
    v_add_f32 v106, v116, v98
    v_add_f32 v107, v117, v99
    v_sub_f32 v130, v88, v122
    v_sub_f32 v131, v89, v123
    v_sub_f32 v94, v116, v98
    v_sub_f32 v95, v117, v99
    v_add_f32 v102, v112, v84
    v_add_f32 v103, v113, v85
    v_add_f32 v124, v90, v96
    v_add_f32 v125, v91, v97
    v_add_f32 v112, v130, v108
    v_sub_f32 v113, v131, v109
    v_add_f32 v90, v94, v104
    v_sub_f32 v91, v95, v105
    v_sub_f32 v84, v130, v108
    v_add_f32 v85, v131, v109
    v_sub_f32 v96, v94, v104
    v_add_f32 v97, v95, v105
    v_add_f32 v88, v118, v102
    v_add_f32 v89, v119, v103
    v_add_f32 v116, v106, v124
    v_add_f32 v117, v107, v125
    v_sub_f32 v122, v118, v102
    v_sub_f32 v123, v119, v103
    v_sub_f32 v98, v106, v124
    v_sub_f32 v99, v107, v125
    s_waitcnt vmcnt(1)
    v_lshlrev_b32 v114, 16, v8
    v_and_b32 v115, 0xffff0000, v8
    v_lshlrev_b32 v86, 16, v9
    v_and_b32 v87, 0xffff0000, v9
    v_lshlrev_b32 v100, 16, v10
    v_and_b32 v101, 0xffff0000, v10
    v_lshlrev_b32 v110, 16, v11
    v_and_b32 v111, 0xffff0000, v11
    v_lshlrev_b32 v120, 16, v12
    v_and_b32 v121, 0xffff0000, v12
    v_lshlrev_b32 v128, 16, v13
    v_and_b32 v129, 0xffff0000, v13
    v_lshlrev_b32 v126, 16, v14
    v_and_b32 v127, 0xffff0000, v14
    v_lshlrev_b32 v92, 16, v15
    v_and_b32 v93, 0xffff0000, v15
    v_mul_f32 v118, v88, v114
    v_mul_f32 v119, v89, v114
    v_mul_f32 v130, v112, v86
    v_mul_f32 v131, v113, v86
    v_mul_f32 v102, v122, v100
    v_mul_f32 v103, v123, v100
    v_mul_f32 v108, v84, v110
    v_mul_f32 v109, v85, v110
    v_mul_f32 v106, v116, v120
    v_mul_f32 v107, v117, v120
    v_mul_f32 v94, v90, v128
    v_mul_f32 v95, v91, v128
    v_mul_f32 v124, v98, v126
    v_mul_f32 v125, v99, v126
    v_mul_f32 v104, v96, v92
    v_mul_f32 v105, v97, v92
    v_fma_f32 v118, -v89, v115, v118
    v_fma_f32 v119, v88, v115, v119
    v_fma_f32 v130, -v113, v87, v130
    v_fma_f32 v131, v112, v87, v131
    v_fma_f32 v102, -v123, v101, v102
    v_fma_f32 v103, v122, v101, v103
    v_fma_f32 v108, -v85, v111, v108
    v_fma_f32 v109, v84, v111, v109
    v_fma_f32 v106, -v117, v121, v106
    v_fma_f32 v107, v116, v121, v107
    v_fma_f32 v94, -v91, v129, v94
    v_fma_f32 v95, v90, v129, v95
    v_fma_f32 v124, -v99, v127, v124
    v_fma_f32 v125, v98, v127, v125
    v_fma_f32 v104, -v97, v93, v104
    v_fma_f32 v105, v96, v93, v105
    v_sub_f32 v84, v131, v109
    v_sub_f32 v85, v130, v108
    v_sub_f32 v96, v95, v105
    v_sub_f32 v97, v94, v104
    v_add_f32 v88, v118, v102
    v_add_f32 v89, v119, v103
    v_add_f32 v116, v106, v124
    v_add_f32 v117, v107, v125
    v_sub_f32 v112, v118, v102
    v_sub_f32 v113, v119, v103
    v_sub_f32 v90, v106, v124
    v_sub_f32 v91, v107, v125
    v_add_f32 v122, v130, v108
    v_add_f32 v123, v131, v109
    v_add_f32 v98, v94, v104
    v_add_f32 v99, v95, v105
    v_sub_f32 v130, v112, v84
    v_add_f32 v131, v113, v85
    v_sub_f32 v94, v90, v96
    v_add_f32 v95, v91, v97
    v_add_f32 v108, v112, v84
    v_sub_f32 v109, v113, v85
    v_add_f32 v104, v90, v96
    v_sub_f32 v105, v91, v97
    v_add_f32 v118, v88, v122
    v_add_f32 v119, v89, v123
    v_add_f32 v106, v116, v98
    v_add_f32 v107, v117, v99
    v_sub_f32 v102, v88, v122
    v_sub_f32 v103, v89, v123
    v_sub_f32 v124, v116, v98
    v_sub_f32 v125, v117, v99
    ds_write_b64 v71, v[118:119] offset:0
    ds_write_b64 v71, v[130:131] offset:8
    ds_write_b64 v71, v[102:103] offset:16
    ds_write_b64 v71, v[108:109] offset:24
    ds_write_b64 v71, v[106:107] offset:1056
    ds_write_b64 v71, v[94:95] offset:1064
    ds_write_b64 v71, v[124:125] offset:1072
    ds_write_b64 v71, v[104:105] offset:1080
    s_waitcnt lgkmcnt(0)
    ds_read_b64 v[118:119], v70 offset:0
    ds_read_b64 v[130:131], v70 offset:264
    ds_read_b64 v[102:103], v70 offset:528
    ds_read_b64 v[108:109], v70 offset:792
    ds_read_b64 v[106:107], v70 offset:1056
    ds_read_b64 v[94:95], v70 offset:1320
    ds_read_b64 v[124:125], v70 offset:1584
    ds_read_b64 v[104:105], v70 offset:1848
    s_waitcnt lgkmcnt(0)
    v_mul_f32 v114, v130, v48
    v_mul_f32 v115, v131, v48
    v_mul_f32 v86, v102, v50
    v_mul_f32 v87, v103, v50
    v_mul_f32 v100, v108, v52
    v_mul_f32 v101, v109, v52
    v_mul_f32 v110, v106, v54
    v_mul_f32 v111, v107, v54
    v_mul_f32 v120, v94, v56
    v_mul_f32 v121, v95, v56
    v_mul_f32 v128, v124, v58
    v_mul_f32 v129, v125, v58
    v_mul_f32 v126, v104, v60
    v_mul_f32 v127, v105, v60
    v_fma_f32 v114, v131, v49, v114
    v_fma_f32 v115, -v130, v49, v115
    v_fma_f32 v86, v103, v51, v86
    v_fma_f32 v87, -v102, v51, v87
    v_fma_f32 v100, v109, v53, v100
    v_fma_f32 v101, -v108, v53, v101
    v_fma_f32 v110, v107, v55, v110
    v_fma_f32 v111, -v106, v55, v111
    v_fma_f32 v120, v95, v57, v120
    v_fma_f32 v121, -v94, v57, v121
    v_fma_f32 v128, v125, v59, v128
    v_fma_f32 v129, -v124, v59, v129
    v_fma_f32 v126, v105, v61, v126
    v_fma_f32 v127, -v104, v61, v127
    v_sub_f32 v116, v101, v127
    v_sub_f32 v117, v100, v126
    v_sub_f32 v84, v87, v129
    v_sub_f32 v85, v86, v128
    v_add_f32 v92, v118, v110
    v_add_f32 v93, v119, v111
    v_add_f32 v88, v114, v120
    v_add_f32 v89, v115, v121
    v_add_f32 v112, v86, v128
    v_add_f32 v113, v87, v129
    v_add_f32 v122, v100, v126
    v_add_f32 v123, v101, v127
    v_sub_f32 v120, v114, v120
    v_sub_f32 v121, v115, v121
    v_sub_f32 v110, v118, v110
    v_sub_f32 v111, v119, v111
    v_sub_f32 v118, v89, v123
    v_sub_f32 v119, v88, v122
    v_sub_f32 v114, v120, v116
    v_add_f32 v115, v121, v117
    v_add_f32 v86, v120, v116
    v_sub_f32 v87, v121, v117
    v_add_f32 v126, v92, v112
    v_add_f32 v127, v93, v113
    v_sub_f32 v90, v92, v112
    v_sub_f32 v91, v93, v113
    v_add_f32 v98, v88, v122
    v_add_f32 v99, v89, v123
    v_sub_f32 v120, v114, v115
    v_add_f32 v121, v115, v114
    v_add_f32 v116, v86, v87
    v_sub_f32 v117, v87, v86
    v_sub_f32 v100, v110, v84
    v_add_f32 v101, v111, v85
    v_add_f32 v128, v110, v84
    v_sub_f32 v129, v111, v85
    v_add_f32 v92, v126, v98
    v_add_f32 v93, v127, v99
    v_sub_f32 v112, v126, v98
    v_sub_f32 v113, v127, v99
    v_sub_f32 v88, v90, v118
    v_add_f32 v89, v91, v119
    v_add_f32 v122, v90, v118
    v_sub_f32 v123, v91, v119
    v_fma_f32 v110, v120, s30, v100
    v_fma_f32 v111, v121, s30, v101
    v_fma_f32 v84, -v120, s30, v100
    v_fma_f32 v85, -v121, s30, v101
    v_fma_f32 v114, -v116, s30, v128
    v_fma_f32 v115, -v117, s30, v129
    v_fma_f32 v86, v116, s30, v128
    v_fma_f32 v87, v117, s30, v129
    ds_write_b64 v69, v[92:93] offset:0
    ds_write_b64 v69, v[110:111] offset:32
    ds_write_b64 v69, v[88:89] offset:64
    ds_write_b64 v69, v[114:115] offset:96
    ds_write_b64 v69, v[112:113] offset:128
    ds_write_b64 v69, v[84:85] offset:160
    ds_write_b64 v69, v[122:123] offset:192
    ds_write_b64 v69, v[86:87] offset:224
    s_waitcnt lgkmcnt(0)
    ds_read_b64 v[92:93], v68 offset:0
    ds_read_b64 v[110:111], v68 offset:288
    ds_read_b64 v[88:89], v68 offset:576
    ds_read_b64 v[114:115], v68 offset:864
    ds_read_b64 v[112:113], v68 offset:1152
    ds_read_b64 v[84:85], v68 offset:1440
    ds_read_b64 v[122:123], v68 offset:1728
    ds_read_b64 v[86:87], v68 offset:2016
    s_waitcnt lgkmcnt(0)
    v_mul_f32 v96, v110, v34
    v_mul_f32 v97, v111, v34
    v_mul_f32 v130, v88, v36
    v_mul_f32 v131, v89, v36
    v_mul_f32 v102, v114, v38
    v_mul_f32 v103, v115, v38
    v_mul_f32 v108, v112, v40
    v_mul_f32 v109, v113, v40
    v_mul_f32 v106, v84, v42
    v_mul_f32 v107, v85, v42
    v_mul_f32 v94, v122, v44
    v_mul_f32 v95, v123, v44
    v_mul_f32 v124, v86, v46
    v_mul_f32 v125, v87, v46
    v_fma_f32 v96, v111, v35, v96
    v_fma_f32 v97, -v110, v35, v97
    v_fma_f32 v130, v89, v37, v130
    v_fma_f32 v131, -v88, v37, v131
    v_fma_f32 v102, v115, v39, v102
    v_fma_f32 v103, -v114, v39, v103
    v_fma_f32 v108, v113, v41, v108
    v_fma_f32 v109, -v112, v41, v109
    v_fma_f32 v106, v85, v43, v106
    v_fma_f32 v107, -v84, v43, v107
    v_fma_f32 v94, v123, v45, v94
    v_fma_f32 v95, -v122, v45, v95
    v_fma_f32 v124, v87, v47, v124
    v_fma_f32 v125, -v86, v47, v125
    v_sub_f32 v90, v103, v125
    v_sub_f32 v91, v102, v124
    v_sub_f32 v126, v131, v95
    v_sub_f32 v127, v130, v94
    v_add_f32 v104, v92, v108
    v_add_f32 v105, v93, v109
    v_add_f32 v118, v96, v106
    v_add_f32 v119, v97, v107
    v_add_f32 v100, v130, v94
    v_add_f32 v101, v131, v95
    v_add_f32 v128, v102, v124
    v_add_f32 v129, v103, v125
    v_sub_f32 v106, v96, v106
    v_sub_f32 v107, v97, v107
    v_sub_f32 v108, v92, v108
    v_sub_f32 v109, v93, v109
    v_sub_f32 v92, v119, v129
    v_sub_f32 v93, v118, v128
    v_sub_f32 v96, v106, v90
    v_add_f32 v97, v107, v91
    v_add_f32 v130, v106, v90
    v_sub_f32 v131, v107, v91
    v_add_f32 v124, v104, v100
    v_add_f32 v125, v105, v101
    v_sub_f32 v98, v104, v100
    v_sub_f32 v99, v105, v101
    v_add_f32 v120, v118, v128
    v_add_f32 v121, v119, v129
    v_sub_f32 v106, v96, v97
    v_add_f32 v107, v97, v96
    v_add_f32 v90, v130, v131
    v_sub_f32 v91, v131, v130
    v_sub_f32 v102, v108, v126
    v_add_f32 v103, v109, v127
    v_add_f32 v94, v108, v126
    v_sub_f32 v95, v109, v127
    v_add_f32 v104, v124, v120
    v_add_f32 v105, v125, v121
    v_sub_f32 v100, v124, v120
    v_sub_f32 v101, v125, v121
    v_sub_f32 v118, v98, v92
    v_add_f32 v119, v99, v93
    v_add_f32 v128, v98, v92
    v_sub_f32 v129, v99, v93
    v_fma_f32 v108, v106, s30, v102
    v_fma_f32 v109, v107, s30, v103
    v_fma_f32 v126, -v106, s30, v102
    v_fma_f32 v127, -v107, s30, v103
    v_fma_f32 v96, -v90, s30, v94
    v_fma_f32 v97, -v91, s30, v95
    v_fma_f32 v130, v90, s30, v94
    v_fma_f32 v131, v91, s30, v95
    ds_write_b64 v68, v[104:105] offset:0
    ds_write_b64 v68, v[108:109] offset:256
    ds_write_b64 v68, v[118:119] offset:512
    ds_write_b64 v68, v[96:97] offset:768
    ds_write_b64 v68, v[100:101] offset:1024
    ds_write_b64 v68, v[126:127] offset:1280
    ds_write_b64 v68, v[128:129] offset:1536
    ds_write_b64 v68, v[130:131] offset:1792
    s_waitcnt lgkmcnt(0)
    s_barrier
    ds_read_b64 v[104:105], v1 offset:0
    ds_read_b64 v[108:109], v1 offset:2304
    ds_read_b64 v[118:119], v1 offset:4608
    ds_read_b64 v[96:97], v1 offset:6912
    ds_read_b64 v[100:101], v1 offset:9216
    ds_read_b64 v[126:127], v1 offset:11520
    ds_read_b64 v[128:129], v1 offset:13824
    ds_read_b64 v[130:131], v1 offset:16128
    s_waitcnt lgkmcnt(0)
    v_mul_f32 v116, v108, v20
    v_mul_f32 v117, v109, v20
    v_mul_f32 v110, v118, v22
    v_mul_f32 v111, v119, v22
    v_mul_f32 v88, v96, v24
    v_mul_f32 v89, v97, v24
    v_mul_f32 v114, v100, v26
    v_mul_f32 v115, v101, v26
    v_mul_f32 v112, v126, v28
    v_mul_f32 v113, v127, v28
    v_mul_f32 v84, v128, v30
    v_mul_f32 v85, v129, v30
    v_mul_f32 v122, v130, v32
    v_mul_f32 v123, v131, v32
    v_fma_f32 v116, v109, v21, v116
    v_fma_f32 v117, -v108, v21, v117
    v_fma_f32 v110, v119, v23, v110
    v_fma_f32 v111, -v118, v23, v111
    v_fma_f32 v88, v97, v25, v88
    v_fma_f32 v89, -v96, v25, v89
    v_fma_f32 v114, v101, v27, v114
    v_fma_f32 v115, -v100, v27, v115
    v_fma_f32 v112, v127, v29, v112
    v_fma_f32 v113, -v126, v29, v113
    v_fma_f32 v84, v129, v31, v84
    v_fma_f32 v85, -v128, v31, v85
    v_fma_f32 v122, v131, v33, v122
    v_fma_f32 v123, -v130, v33, v123
    v_sub_f32 v98, v89, v123
    v_sub_f32 v99, v88, v122
    v_sub_f32 v124, v111, v85
    v_sub_f32 v125, v110, v84
    v_add_f32 v86, v104, v114
    v_add_f32 v87, v105, v115
    v_add_f32 v92, v116, v112
    v_add_f32 v93, v117, v113
    v_add_f32 v102, v110, v84
    v_add_f32 v103, v111, v85
    v_add_f32 v94, v88, v122
    v_add_f32 v95, v89, v123
    v_sub_f32 v112, v116, v112
    v_sub_f32 v113, v117, v113
    v_sub_f32 v114, v104, v114
    v_sub_f32 v115, v105, v115
    v_sub_f32 v104, v93, v95
    v_sub_f32 v105, v92, v94
    v_sub_f32 v116, v112, v98
    v_add_f32 v117, v113, v99
    v_add_f32 v110, v112, v98
    v_sub_f32 v111, v113, v99
    v_add_f32 v122, v86, v102
    v_add_f32 v123, v87, v103
    v_sub_f32 v120, v86, v102
    v_sub_f32 v121, v87, v103
    v_add_f32 v106, v92, v94
    v_add_f32 v107, v93, v95
    v_sub_f32 v112, v116, v117
    v_add_f32 v113, v117, v116
    v_add_f32 v98, v110, v111
    v_sub_f32 v99, v111, v110
    v_sub_f32 v88, v114, v124
    v_add_f32 v89, v115, v125
    v_add_f32 v84, v114, v124
    v_sub_f32 v85, v115, v125
    v_add_f32 v86, v122, v106
    v_add_f32 v87, v123, v107
    v_sub_f32 v102, v122, v106
    v_sub_f32 v103, v123, v107
    v_sub_f32 v92, v120, v104
    v_add_f32 v93, v121, v105
    v_add_f32 v94, v120, v104
    v_sub_f32 v95, v121, v105
    v_fma_f32 v114, v112, s30, v88
    v_fma_f32 v115, v113, s30, v89
    v_fma_f32 v124, -v112, s30, v88
    v_fma_f32 v125, -v113, s30, v89
    v_fma_f32 v116, -v98, s30, v84
    v_fma_f32 v117, -v99, s30, v85
    v_fma_f32 v110, v98, s30, v84
    v_fma_f32 v111, v99, s30, v85
    v_cvt_pk_bf16_f32 v8, v86, v87
    v_cvt_pk_bf16_f32 v9, v114, v115
    v_cvt_pk_bf16_f32 v10, v92, v93
    v_cvt_pk_bf16_f32 v11, v116, v117
    v_cvt_pk_bf16_f32 v12, v102, v103
    v_cvt_pk_bf16_f32 v13, v124, v125
    v_cvt_pk_bf16_f32 v14, v94, v95
    v_cvt_pk_bf16_f32 v15, v110, v111
    s_lshl_b32 s42, s41, 13
    s_add_u32 s42, s42, 17825792
    s_add_u32 s43, s42, 4096
    v_lshlrev_b32 v1, 2, v0
    s_cmp_eq_u32 s41, 0
    s_cbranch_scc1 L1_fft_spst
    buffer_store_dword v8, v1, s[24:27], s42 offen offset:0 sc1
    buffer_store_dword v9, v1, s[24:27], s42 offen offset:1024 sc1
    buffer_store_dword v10, v1, s[24:27], s42 offen offset:2048 sc1
    buffer_store_dword v11, v1, s[24:27], s42 offen offset:3072 sc1
    buffer_store_dword v12, v1, s[24:27], s43 offen offset:0 sc1
    buffer_store_dword v13, v1, s[24:27], s43 offen offset:1024 sc1
    buffer_store_dword v14, v1, s[24:27], s43 offen offset:2048 sc1
    buffer_store_dword v15, v1, s[24:27], s43 offen offset:3072 sc1
    s_endpgm
L1_fft_spst:
    s_lshr_b32 s44, s40, 7
    v_add_u32 v1, s44, v1
    buffer_store_short v8, v1, s[24:27], s42 offen offset:0
    buffer_store_short v9, v1, s[24:27], s42 offen offset:1024
    buffer_store_short v10, v1, s[24:27], s42 offen offset:2048
    buffer_store_short v11, v1, s[24:27], s42 offen offset:3072
    buffer_store_short v12, v1, s[24:27], s43 offen offset:0
    buffer_store_short v13, v1, s[24:27], s43 offen offset:1024
    buffer_store_short v14, v1, s[24:27], s43 offen offset:2048
    buffer_store_short v15, v1, s[24:27], s43 offen offset:3072
    s_endpgm
L1_gemm:
    s_and_b32 s40, s2, 7
    s_lshr_b32 s41, s2, 3
    s_and_b32 s42, s40, 1
    s_lshl_b32 s42, s42, 2
    s_and_b32 s43, s41, 3
    s_add_u32 s42, s42, s43
    s_lshr_b32 s43, s40, 1
    s_mul_i32 s43, s43, 7
    s_lshr_b32 s44, s41, 2
    s_add_u32 s43, s43, s44
    v_lshrrev_b32 v1, 6, v0
    s_nop 0
    v_readfirstlane_b32 s44, v1
    v_and_b32 v1, 63, v0
    s_lshl_b32 s46, s42, 3
    s_lshl_b32 s47, s44, 1
    s_add_u32 s46, s46, s47
    s_lshl_b32 s48, s46, 15
    s_add_u32 s49, s48, 32768
    v_bfe_u32 v4, v1, 5, 1
    v_bfe_u32 v5, v1, 4, 1
    v_bfe_u32 v6, v1, 3, 1
    v_lshlrev_b32 v7, 7, v4
    v_lshl_add_u32 v7, v5, 6, v7
    v_add_u32 v7, v7, v6
    v_mul_u32_u24 v7, 3584, v7
    s_lshl_b32 s45, s43, 7
    v_add_u32 v7, s45, v7
    v_and_b32 v8, 7, v1
    v_xor_b32 v8, v8, v5
    s_and_b32 s45, s44, 1
    s_lshl_b32 s45, s45, 2
    v_xor_b32 v8, s45, v8
    v_lshl_add_u32 v2, v8, 4, v7
    s_lshr_b32 s50, s44, 1
    s_lshl_b32 s50, s50, 1
    s_and_b32 s51, s44, 1
    s_lshl_b32 s51, s51, 8
    s_add_u32 s50, s50, s51
    s_mul_i32 s50, s50, 3584
    s_lshl_b32 s51, s44, 10
    v_lshrrev_b32 v4, 4, v1
    v_and_b32 v5, 15, v1
    v_lshlrev_b32 v11, 9, v4
    v_lshl_add_u32 v11, v5, 4, v11
    s_waitcnt lgkmcnt(0)
    s_mov_b32 s24, s10
    s_and_b32 s25, s11, 0xffff
    s_mov_b32 s26, 0x10000000
    s_mov_b32 s27, 0x00020000
    s_mov_b32 s12, s4
    s_and_b32 s13, s5, 0xffff
    s_mov_b32 s14, 0x1c0000
    s_mov_b32 s15, 0x00020000
    s_mov_b32 s16, s6
    s_and_b32 s17, s7, 0xffff
    s_mov_b32 s18, 0x1c0000
    s_mov_b32 s19, 0x00020000
    s_mov_b32 s20, s8
    s_and_b32 s21, s9, 0xffff
    s_mov_b32 s22, 0x1c0000
    s_mov_b32 s23, 0x00020000
    s_add_u32 s54, s48, 0
    buffer_load_dwordx4 v[64:67], v11, s[24:27], s54 offen offset:0
    buffer_load_dwordx4 v[68:71], v11, s[24:27], s54 offen offset:256
    s_add_u32 s55, s49, 0
    buffer_load_dwordx4 v[72:75], v11, s[24:27], s55 offen offset:0
    buffer_load_dwordx4 v[76:79], v11, s[24:27], s55 offen offset:256
    s_add_u32 s52, s50, 0
    s_add_u32 m0, s51, 0
    s_nop 0
    buffer_load_dwordx4 v2, s[12:15], s52 offen lds
    s_add_u32 s52, s50, 0
    s_add_u32 m0, s51, 8192
    s_nop 0
    buffer_load_dwordx4 v2, s[16:19], s52 offen lds
    s_add_u32 s52, s50, 14336
    s_add_u32 m0, s51, 4096
    s_nop 0
    buffer_load_dwordx4 v2, s[12:15], s52 offen lds
    s_add_u32 s52, s50, 14336
    s_add_u32 m0, s51, 12288
    s_nop 0
    buffer_load_dwordx4 v2, s[16:19], s52 offen lds
    buffer_load_dwordx4 v[80:83], v11, s[24:27], s54 offen offset:2048
    buffer_load_dwordx4 v[84:87], v11, s[24:27], s54 offen offset:2304
    buffer_load_dwordx4 v[88:91], v11, s[24:27], s55 offen offset:2048
    buffer_load_dwordx4 v[92:95], v11, s[24:27], s55 offen offset:2304
    v_bfe_u32 v6, v1, 2, 2
    v_lshl_add_u32 v8, v4, 3, v6
    v_lshlrev_b32 v8, 7, v8
    v_and_b32 v7, 1, v1
    v_lshl_add_u32 v8, v7, 3, v8
    v_lshrrev_b32 v9, 1, v6
    v_and_b32 v4, 1, v4
    v_lshl_add_u32 v9, v4, 2, v9
    v_and_b32 v7, 2, v1
    v_xor_b32 v9, v9, v7
    v_xor_b32 v10, 0, v9
    v_lshl_add_u32 v12, v10, 4, v8
    v_xor_b32 v10, 1, v9
    v_lshl_add_u32 v13, v10, 4, v8
    v_xor_b32 v10, 4, v9
    v_lshl_add_u32 v14, v10, 4, v8
    v_xor_b32 v10, 5, v9
    v_lshl_add_u32 v15, v10, 4, v8
    v_lshlrev_b32 v16, 4, v1
    v_and_b32 v18, 7, v1
    v_lshlrev_b32 v18, 7, v18
    s_lshl_b32 s56, s44, 10
    v_add_u32 v18, s56, v18
    s_lshl_b32 s56, s41, 16
    s_mul_i32 s58, s41, 146
    s_min_u32 s58, s58, 3936
    s_lshl_b32 s58, s58, 7
    s_add_u32 s58, s58, 19922944
    s_waitcnt vmcnt(4)
    s_barrier
    s_setprio 0
    ds_read_b64_tr_b16 v[32:33], v12 offset:0
    ds_read_b64_tr_b16 v[34:35], v12 offset:512
    ds_read_b64_tr_b16 v[48:49], v12 offset:8192
    ds_read_b64_tr_b16 v[50:51], v12 offset:8704
    ds_read_b64_tr_b16 v[36:37], v13 offset:0
    ds_read_b64_tr_b16 v[38:39], v13 offset:512
    ds_read_b64_tr_b16 v[52:53], v13 offset:8192
    ds_read_b64_tr_b16 v[54:55], v13 offset:8704
    ds_read_b64_tr_b16 v[40:41], v14 offset:0
    ds_read_b64_tr_b16 v[42:43], v14 offset:512
    ds_read_b64_tr_b16 v[56:57], v14 offset:8192
    ds_read_b64_tr_b16 v[58:59], v14 offset:8704
    ds_read_b64_tr_b16 v[44:45], v15 offset:0
    ds_read_b64_tr_b16 v[46:47], v15 offset:512
    s_waitcnt lgkmcnt(12)
    ds_read_b64_tr_b16 v[60:61], v15 offset:8192
    ds_read_b64_tr_b16 v[62:63], v15 offset:8704
    s_mul_i32 s60, s46, 112
    s_lshl_b32 s61, s43, 1
    s_add_u32 s60, s60, s61
    s_lshl_b32 s60, s60, 10
    s_add_u32 s60, s60, 9437184
    s_add_u32 s61, s60, 57344
    s_add_u32 s62, s60, 114688
    s_add_u32 s63, s60, 172032
    v_mfma_f32_16x16x32_bf16 v[128:131], v[32:35], v[64:67], 0
    v_mfma_f32_16x16x32_bf16 v[132:135], v[32:35], v[68:71], 0
    s_add_u32 s52, s50, 28672
    s_add_u32 m0, s51, 16384
    s_nop 0
    buffer_load_dwordx4 v2, s[12:15], s52 offen lds
    v_mfma_f32_16x16x32_bf16 v[136:139], v[32:35], v[72:75], 0
    v_mfma_f32_16x16x32_bf16 v[140:143], v[32:35], v[76:79], 0
    s_add_u32 s52, s50, 28672
    s_add_u32 m0, s51, 24576
    s_nop 0
    buffer_load_dwordx4 v2, s[16:19], s52 offen lds
    s_waitcnt lgkmcnt(12)
    v_mfma_f32_16x16x32_bf16 v[192:195], v[48:51], v[64:67], 0
    ds_read_b64_tr_b16 v[32:33], v12 offset:4096
    v_mfma_f32_16x16x32_bf16 v[196:199], v[48:51], v[68:71], 0
    s_add_u32 s52, s50, 43008
    s_add_u32 m0, s51, 20480
    s_nop 0
    buffer_load_dwordx4 v2, s[12:15], s52 offen lds
    v_mfma_f32_16x16x32_bf16 v[200:203], v[48:51], v[72:75], 0
    ds_read_b64_tr_b16 v[34:35], v12 offset:4608
    v_mfma_f32_16x16x32_bf16 v[204:207], v[48:51], v[76:79], 0
    s_add_u32 s52, s50, 43008
    s_add_u32 m0, s51, 28672
    s_nop 0
    buffer_load_dwordx4 v2, s[16:19], s52 offen lds
    s_waitcnt lgkmcnt(12)
    v_mfma_f32_16x16x32_bf16 v[144:147], v[36:39], v[64:67], 0
    ds_read_b64_tr_b16 v[48:49], v12 offset:12288
    v_mfma_f32_16x16x32_bf16 v[148:151], v[36:39], v[68:71], 0
    s_add_u32 s54, s48, 4096
    buffer_load_dwordx4 v[96:99], v11, s[24:27], s54 offen offset:0
    v_mfma_f32_16x16x32_bf16 v[152:155], v[36:39], v[72:75], 0
    ds_read_b64_tr_b16 v[50:51], v12 offset:12800
    v_mfma_f32_16x16x32_bf16 v[156:159], v[36:39], v[76:79], 0
    buffer_load_dwordx4 v[100:103], v11, s[24:27], s54 offen offset:256
    s_waitcnt lgkmcnt(12)
    v_mfma_f32_16x16x32_bf16 v[208:211], v[52:55], v[64:67], 0
    ds_read_b64_tr_b16 v[36:37], v13 offset:4096
    v_mfma_f32_16x16x32_bf16 v[212:215], v[52:55], v[68:71], 0
    s_add_u32 s55, s49, 4096
    buffer_load_dwordx4 v[104:107], v11, s[24:27], s55 offen offset:0
    v_mfma_f32_16x16x32_bf16 v[216:219], v[52:55], v[72:75], 0
    ds_read_b64_tr_b16 v[38:39], v13 offset:4608
    v_mfma_f32_16x16x32_bf16 v[220:223], v[52:55], v[76:79], 0
    buffer_load_dwordx4 v[108:111], v11, s[24:27], s55 offen offset:256
    s_waitcnt lgkmcnt(12)
    v_mfma_f32_16x16x32_bf16 v[160:163], v[40:43], v[64:67], 0
    ds_read_b64_tr_b16 v[52:53], v13 offset:12288
    v_mfma_f32_16x16x32_bf16 v[164:167], v[40:43], v[68:71], 0
    buffer_load_dwordx4 v[112:115], v11, s[24:27], s54 offen offset:2048
    v_mfma_f32_16x16x32_bf16 v[168:171], v[40:43], v[72:75], 0
    ds_read_b64_tr_b16 v[54:55], v13 offset:12800
    v_mfma_f32_16x16x32_bf16 v[172:175], v[40:43], v[76:79], 0
    buffer_load_dwordx4 v[116:119], v11, s[24:27], s54 offen offset:2304
    s_waitcnt lgkmcnt(12)
    v_mfma_f32_16x16x32_bf16 v[224:227], v[56:59], v[64:67], 0
    ds_read_b64_tr_b16 v[40:41], v14 offset:4096
    v_mfma_f32_16x16x32_bf16 v[228:231], v[56:59], v[68:71], 0
    buffer_load_dwordx4 v[120:123], v11, s[24:27], s55 offen offset:2048
    v_mfma_f32_16x16x32_bf16 v[232:235], v[56:59], v[72:75], 0
    ds_read_b64_tr_b16 v[42:43], v14 offset:4608
    v_mfma_f32_16x16x32_bf16 v[236:239], v[56:59], v[76:79], 0
    buffer_load_dwordx4 v[124:127], v11, s[24:27], s55 offen offset:2304
    s_waitcnt lgkmcnt(12)
    v_mfma_f32_16x16x32_bf16 v[176:179], v[44:47], v[64:67], 0
    ds_read_b64_tr_b16 v[56:57], v14 offset:12288
    v_mfma_f32_16x16x32_bf16 v[180:183], v[44:47], v[68:71], 0
    s_add_u32 s52, s50, 57344
    s_add_u32 m0, s51, 32768
    s_nop 0
    buffer_load_dwordx4 v2, s[12:15], s52 offen lds
    v_mfma_f32_16x16x32_bf16 v[184:187], v[44:47], v[72:75], 0
    ds_read_b64_tr_b16 v[58:59], v14 offset:12800
    v_mfma_f32_16x16x32_bf16 v[188:191], v[44:47], v[76:79], 0
    s_add_u32 s52, s50, 57344
    s_add_u32 m0, s51, 40960
    s_nop 0
    buffer_load_dwordx4 v2, s[16:19], s52 offen lds
    s_waitcnt lgkmcnt(12)
    v_mfma_f32_16x16x32_bf16 v[240:243], v[60:63], v[64:67], 0
    ds_read_b64_tr_b16 v[44:45], v15 offset:4096
    v_mfma_f32_16x16x32_bf16 v[244:247], v[60:63], v[68:71], 0
    s_add_u32 s52, s50, 71680
    s_add_u32 m0, s51, 36864
    s_nop 0
    buffer_load_dwordx4 v2, s[12:15], s52 offen lds
    v_mfma_f32_16x16x32_bf16 v[248:251], v[60:63], v[72:75], 0
    ds_read_b64_tr_b16 v[46:47], v15 offset:4608
    v_mfma_f32_16x16x32_bf16 v[252:255], v[60:63], v[76:79], 0
    s_add_u32 s52, s50, 71680
    s_add_u32 m0, s51, 45056
    s_nop 0
    buffer_load_dwordx4 v2, s[16:19], s52 offen lds
    s_waitcnt vmcnt(12)
    s_barrier
    s_waitcnt lgkmcnt(12)
    v_mfma_f32_16x16x32_bf16 v[128:131], v[32:35], v[80:83], v[128:131]
    ds_read_b64_tr_b16 v[60:61], v15 offset:12288
    v_mfma_f32_16x16x32_bf16 v[132:135], v[32:35], v[84:87], v[132:135]
    s_add_u32 s54, s48, 8192
    buffer_load_dwordx4 v[64:67], v11, s[24:27], s54 offen offset:0
    v_mfma_f32_16x16x32_bf16 v[136:139], v[32:35], v[88:91], v[136:139]
    ds_read_b64_tr_b16 v[62:63], v15 offset:12800
    v_mfma_f32_16x16x32_bf16 v[140:143], v[32:35], v[92:95], v[140:143]
    s_waitcnt lgkmcnt(12)
    v_mfma_f32_16x16x32_bf16 v[192:195], v[48:51], v[80:83], v[192:195]
    ds_read_b64_tr_b16 v[32:33], v12 offset:16384
    v_mfma_f32_16x16x32_bf16 v[196:199], v[48:51], v[84:87], v[196:199]
    buffer_load_dwordx4 v[68:71], v11, s[24:27], s54 offen offset:256
    v_mfma_f32_16x16x32_bf16 v[200:203], v[48:51], v[88:91], v[200:203]
    ds_read_b64_tr_b16 v[34:35], v12 offset:16896
    v_mfma_f32_16x16x32_bf16 v[204:207], v[48:51], v[92:95], v[204:207]
    s_waitcnt lgkmcnt(12)
    v_mfma_f32_16x16x32_bf16 v[144:147], v[36:39], v[80:83], v[144:147]
    ds_read_b64_tr_b16 v[48:49], v12 offset:24576
    v_mfma_f32_16x16x32_bf16 v[148:151], v[36:39], v[84:87], v[148:151]
    s_add_u32 s55, s49, 8192
    buffer_load_dwordx4 v[72:75], v11, s[24:27], s55 offen offset:0
    v_mfma_f32_16x16x32_bf16 v[152:155], v[36:39], v[88:91], v[152:155]
    ds_read_b64_tr_b16 v[50:51], v12 offset:25088
    v_mfma_f32_16x16x32_bf16 v[156:159], v[36:39], v[92:95], v[156:159]
    s_waitcnt lgkmcnt(12)
    v_mfma_f32_16x16x32_bf16 v[208:211], v[52:55], v[80:83], v[208:211]
    ds_read_b64_tr_b16 v[36:37], v13 offset:16384
    v_mfma_f32_16x16x32_bf16 v[212:215], v[52:55], v[84:87], v[212:215]
    buffer_load_dwordx4 v[76:79], v11, s[24:27], s55 offen offset:256
    v_mfma_f32_16x16x32_bf16 v[216:219], v[52:55], v[88:91], v[216:219]
    ds_read_b64_tr_b16 v[38:39], v13 offset:16896
    v_mfma_f32_16x16x32_bf16 v[220:223], v[52:55], v[92:95], v[220:223]
    s_waitcnt lgkmcnt(12)
    v_mfma_f32_16x16x32_bf16 v[160:163], v[40:43], v[80:83], v[160:163]
    ds_read_b64_tr_b16 v[52:53], v13 offset:24576
    v_mfma_f32_16x16x32_bf16 v[164:167], v[40:43], v[84:87], v[164:167]
    s_add_u32 s52, s50, 86016
    s_add_u32 m0, s51, 49152
    s_nop 0
    buffer_load_dwordx4 v2, s[12:15], s52 offen lds
    v_mfma_f32_16x16x32_bf16 v[168:171], v[40:43], v[88:91], v[168:171]
    ds_read_b64_tr_b16 v[54:55], v13 offset:25088
    v_mfma_f32_16x16x32_bf16 v[172:175], v[40:43], v[92:95], v[172:175]
    s_waitcnt lgkmcnt(12)
    v_mfma_f32_16x16x32_bf16 v[224:227], v[56:59], v[80:83], v[224:227]
    ds_read_b64_tr_b16 v[40:41], v14 offset:16384
    v_mfma_f32_16x16x32_bf16 v[228:231], v[56:59], v[84:87], v[228:231]
    v_mfma_f32_16x16x32_bf16 v[232:235], v[56:59], v[88:91], v[232:235]
    ds_read_b64_tr_b16 v[42:43], v14 offset:16896
    v_mfma_f32_16x16x32_bf16 v[236:239], v[56:59], v[92:95], v[236:239]
    s_waitcnt lgkmcnt(12)
    v_mfma_f32_16x16x32_bf16 v[176:179], v[44:47], v[80:83], v[176:179]
    ds_read_b64_tr_b16 v[56:57], v14 offset:24576
    v_mfma_f32_16x16x32_bf16 v[180:183], v[44:47], v[84:87], v[180:183]
    s_add_u32 s52, s50, 86016
    s_add_u32 m0, s51, 57344
    s_nop 0
    buffer_load_dwordx4 v2, s[16:19], s52 offen lds
    v_mfma_f32_16x16x32_bf16 v[184:187], v[44:47], v[88:91], v[184:187]
    ds_read_b64_tr_b16 v[58:59], v14 offset:25088
    v_mfma_f32_16x16x32_bf16 v[188:191], v[44:47], v[92:95], v[188:191]
    s_waitcnt lgkmcnt(12)
    v_mfma_f32_16x16x32_bf16 v[240:243], v[60:63], v[80:83], v[240:243]
    ds_read_b64_tr_b16 v[44:45], v15 offset:16384
    v_mfma_f32_16x16x32_bf16 v[244:247], v[60:63], v[84:87], v[244:247]
    v_mfma_f32_16x16x32_bf16 v[248:251], v[60:63], v[88:91], v[248:251]
    ds_read_b64_tr_b16 v[46:47], v15 offset:16896
    v_mfma_f32_16x16x32_bf16 v[252:255], v[60:63], v[92:95], v[252:255]
    s_waitcnt vmcnt(14)
    s_waitcnt lgkmcnt(12)
    v_mfma_f32_16x16x32_bf16 v[128:131], v[32:35], v[96:99], v[128:131]
    ds_read_b64_tr_b16 v[60:61], v15 offset:24576
    v_mfma_f32_16x16x32_bf16 v[132:135], v[32:35], v[100:103], v[132:135]
    buffer_load_dwordx4 v[80:83], v11, s[24:27], s54 offen offset:2048
    v_mfma_f32_16x16x32_bf16 v[136:139], v[32:35], v[104:107], v[136:139]
    ds_read_b64_tr_b16 v[62:63], v15 offset:25088
    v_mfma_f32_16x16x32_bf16 v[140:143], v[32:35], v[108:111], v[140:143]
    s_waitcnt lgkmcnt(12)
    v_mfma_f32_16x16x32_bf16 v[192:195], v[48:51], v[96:99], v[192:195]
    ds_read_b64_tr_b16 v[32:33], v12 offset:20480
    v_mfma_f32_16x16x32_bf16 v[196:199], v[48:51], v[100:103], v[196:199]
    buffer_load_dwordx4 v[84:87], v11, s[24:27], s54 offen offset:2304
    v_mfma_f32_16x16x32_bf16 v[200:203], v[48:51], v[104:107], v[200:203]
    ds_read_b64_tr_b16 v[34:35], v12 offset:20992
    v_mfma_f32_16x16x32_bf16 v[204:207], v[48:51], v[108:111], v[204:207]
    s_waitcnt lgkmcnt(12)
    v_mfma_f32_16x16x32_bf16 v[144:147], v[36:39], v[96:99], v[144:147]
    ds_read_b64_tr_b16 v[48:49], v12 offset:28672
    v_mfma_f32_16x16x32_bf16 v[148:151], v[36:39], v[100:103], v[148:151]
    buffer_load_dwordx4 v[88:91], v11, s[24:27], s55 offen offset:2048
    v_mfma_f32_16x16x32_bf16 v[152:155], v[36:39], v[104:107], v[152:155]
    ds_read_b64_tr_b16 v[50:51], v12 offset:29184
    v_mfma_f32_16x16x32_bf16 v[156:159], v[36:39], v[108:111], v[156:159]
    s_waitcnt lgkmcnt(12)
    v_mfma_f32_16x16x32_bf16 v[208:211], v[52:55], v[96:99], v[208:211]
    ds_read_b64_tr_b16 v[36:37], v13 offset:20480
    v_mfma_f32_16x16x32_bf16 v[212:215], v[52:55], v[100:103], v[212:215]
    buffer_load_dwordx4 v[92:95], v11, s[24:27], s55 offen offset:2304
    v_mfma_f32_16x16x32_bf16 v[216:219], v[52:55], v[104:107], v[216:219]
    ds_read_b64_tr_b16 v[38:39], v13 offset:20992
    v_mfma_f32_16x16x32_bf16 v[220:223], v[52:55], v[108:111], v[220:223]
    s_waitcnt lgkmcnt(12)
    v_mfma_f32_16x16x32_bf16 v[160:163], v[40:43], v[96:99], v[160:163]
    ds_read_b64_tr_b16 v[52:53], v13 offset:28672
    v_mfma_f32_16x16x32_bf16 v[164:167], v[40:43], v[100:103], v[164:167]
    s_add_u32 s52, s50, 100352
    s_add_u32 m0, s51, 53248
    s_nop 0
    buffer_load_dwordx4 v2, s[12:15], s52 offen lds
    v_mfma_f32_16x16x32_bf16 v[168:171], v[40:43], v[104:107], v[168:171]
    ds_read_b64_tr_b16 v[54:55], v13 offset:29184
    v_mfma_f32_16x16x32_bf16 v[172:175], v[40:43], v[108:111], v[172:175]
    s_waitcnt lgkmcnt(12)
    v_mfma_f32_16x16x32_bf16 v[224:227], v[56:59], v[96:99], v[224:227]
    ds_read_b64_tr_b16 v[40:41], v14 offset:20480
    v_mfma_f32_16x16x32_bf16 v[228:231], v[56:59], v[100:103], v[228:231]
    v_mfma_f32_16x16x32_bf16 v[232:235], v[56:59], v[104:107], v[232:235]
    ds_read_b64_tr_b16 v[42:43], v14 offset:20992
    v_mfma_f32_16x16x32_bf16 v[236:239], v[56:59], v[108:111], v[236:239]
    s_waitcnt lgkmcnt(12)
    v_mfma_f32_16x16x32_bf16 v[176:179], v[44:47], v[96:99], v[176:179]
    ds_read_b64_tr_b16 v[56:57], v14 offset:28672
    v_mfma_f32_16x16x32_bf16 v[180:183], v[44:47], v[100:103], v[180:183]
    s_add_u32 s52, s50, 100352
    s_add_u32 m0, s51, 61440
    s_nop 0
    buffer_load_dwordx4 v2, s[16:19], s52 offen lds
    v_mfma_f32_16x16x32_bf16 v[184:187], v[44:47], v[104:107], v[184:187]
    ds_read_b64_tr_b16 v[58:59], v14 offset:29184
    v_mfma_f32_16x16x32_bf16 v[188:191], v[44:47], v[108:111], v[188:191]
    s_waitcnt lgkmcnt(12)
    v_mfma_f32_16x16x32_bf16 v[240:243], v[60:63], v[96:99], v[240:243]
    ds_read_b64_tr_b16 v[44:45], v15 offset:20480
    v_mfma_f32_16x16x32_bf16 v[244:247], v[60:63], v[100:103], v[244:247]
    v_mfma_f32_16x16x32_bf16 v[248:251], v[60:63], v[104:107], v[248:251]
    ds_read_b64_tr_b16 v[46:47], v15 offset:20992
    v_mfma_f32_16x16x32_bf16 v[252:255], v[60:63], v[108:111], v[252:255]
    s_waitcnt vmcnt(12)
    s_barrier
    s_waitcnt lgkmcnt(12)
    v_mfma_f32_16x16x32_bf16 v[128:131], v[32:35], v[112:115], v[128:131]
    ds_read_b64_tr_b16 v[60:61], v15 offset:28672
    v_mfma_f32_16x16x32_bf16 v[132:135], v[32:35], v[116:119], v[132:135]
    s_add_u32 s54, s48, 12288
    buffer_load_dwordx4 v[96:99], v11, s[24:27], s54 offen offset:0
    v_mfma_f32_16x16x32_bf16 v[136:139], v[32:35], v[120:123], v[136:139]
    ds_read_b64_tr_b16 v[62:63], v15 offset:29184
    v_mfma_f32_16x16x32_bf16 v[140:143], v[32:35], v[124:127], v[140:143]
    s_waitcnt lgkmcnt(12)
    v_mfma_f32_16x16x32_bf16 v[192:195], v[48:51], v[112:115], v[192:195]
    ds_read_b64_tr_b16 v[32:33], v12 offset:32768
    v_mfma_f32_16x16x32_bf16 v[196:199], v[48:51], v[116:119], v[196:199]
    buffer_load_dwordx4 v[100:103], v11, s[24:27], s54 offen offset:256
    v_mfma_f32_16x16x32_bf16 v[200:203], v[48:51], v[120:123], v[200:203]
    ds_read_b64_tr_b16 v[34:35], v12 offset:33280
    v_mfma_f32_16x16x32_bf16 v[204:207], v[48:51], v[124:127], v[204:207]
    s_waitcnt lgkmcnt(12)
    v_mfma_f32_16x16x32_bf16 v[144:147], v[36:39], v[112:115], v[144:147]
    ds_read_b64_tr_b16 v[48:49], v12 offset:40960
    v_mfma_f32_16x16x32_bf16 v[148:151], v[36:39], v[116:119], v[148:151]
    s_add_u32 s55, s49, 12288
    buffer_load_dwordx4 v[104:107], v11, s[24:27], s55 offen offset:0
    v_mfma_f32_16x16x32_bf16 v[152:155], v[36:39], v[120:123], v[152:155]
    ds_read_b64_tr_b16 v[50:51], v12 offset:41472
    v_mfma_f32_16x16x32_bf16 v[156:159], v[36:39], v[124:127], v[156:159]
    s_waitcnt lgkmcnt(12)
    v_mfma_f32_16x16x32_bf16 v[208:211], v[52:55], v[112:115], v[208:211]
    ds_read_b64_tr_b16 v[36:37], v13 offset:32768
    v_mfma_f32_16x16x32_bf16 v[212:215], v[52:55], v[116:119], v[212:215]
    buffer_load_dwordx4 v[108:111], v11, s[24:27], s55 offen offset:256
    v_mfma_f32_16x16x32_bf16 v[216:219], v[52:55], v[120:123], v[216:219]
    ds_read_b64_tr_b16 v[38:39], v13 offset:33280
    v_mfma_f32_16x16x32_bf16 v[220:223], v[52:55], v[124:127], v[220:223]
    s_waitcnt lgkmcnt(12)
    v_mfma_f32_16x16x32_bf16 v[160:163], v[40:43], v[112:115], v[160:163]
    ds_read_b64_tr_b16 v[52:53], v13 offset:40960
    v_mfma_f32_16x16x32_bf16 v[164:167], v[40:43], v[116:119], v[164:167]
    s_add_u32 s52, s50, 114688
    s_add_u32 m0, s51, 0
    s_nop 0
    buffer_load_dwordx4 v2, s[12:15], s52 offen lds
    v_mfma_f32_16x16x32_bf16 v[168:171], v[40:43], v[120:123], v[168:171]
    ds_read_b64_tr_b16 v[54:55], v13 offset:41472
    v_mfma_f32_16x16x32_bf16 v[172:175], v[40:43], v[124:127], v[172:175]
    s_waitcnt lgkmcnt(12)
    v_mfma_f32_16x16x32_bf16 v[224:227], v[56:59], v[112:115], v[224:227]
    ds_read_b64_tr_b16 v[40:41], v14 offset:32768
    v_mfma_f32_16x16x32_bf16 v[228:231], v[56:59], v[116:119], v[228:231]
    v_mfma_f32_16x16x32_bf16 v[232:235], v[56:59], v[120:123], v[232:235]
    ds_read_b64_tr_b16 v[42:43], v14 offset:33280
    v_mfma_f32_16x16x32_bf16 v[236:239], v[56:59], v[124:127], v[236:239]
    s_waitcnt lgkmcnt(12)
    v_mfma_f32_16x16x32_bf16 v[176:179], v[44:47], v[112:115], v[176:179]
    ds_read_b64_tr_b16 v[56:57], v14 offset:40960
    v_mfma_f32_16x16x32_bf16 v[180:183], v[44:47], v[116:119], v[180:183]
    s_add_u32 s52, s50, 114688
    s_add_u32 m0, s51, 8192
    s_nop 0
    buffer_load_dwordx4 v2, s[16:19], s52 offen lds
    v_mfma_f32_16x16x32_bf16 v[184:187], v[44:47], v[120:123], v[184:187]
    ds_read_b64_tr_b16 v[58:59], v14 offset:41472
    v_mfma_f32_16x16x32_bf16 v[188:191], v[44:47], v[124:127], v[188:191]
    s_waitcnt lgkmcnt(12)
    v_mfma_f32_16x16x32_bf16 v[240:243], v[60:63], v[112:115], v[240:243]
    ds_read_b64_tr_b16 v[44:45], v15 offset:32768
    v_mfma_f32_16x16x32_bf16 v[244:247], v[60:63], v[116:119], v[244:247]
    v_mfma_f32_16x16x32_bf16 v[248:251], v[60:63], v[120:123], v[248:251]
    ds_read_b64_tr_b16 v[46:47], v15 offset:33280
    v_mfma_f32_16x16x32_bf16 v[252:255], v[60:63], v[124:127], v[252:255]
    s_waitcnt vmcnt(14)
    s_waitcnt lgkmcnt(12)
    v_mfma_f32_16x16x32_bf16 v[128:131], v[32:35], v[64:67], v[128:131]
    ds_read_b64_tr_b16 v[60:61], v15 offset:40960
    v_mfma_f32_16x16x32_bf16 v[132:135], v[32:35], v[68:71], v[132:135]
    buffer_load_dwordx4 v[112:115], v11, s[24:27], s54 offen offset:2048
    v_mfma_f32_16x16x32_bf16 v[136:139], v[32:35], v[72:75], v[136:139]
    ds_read_b64_tr_b16 v[62:63], v15 offset:41472
    v_mfma_f32_16x16x32_bf16 v[140:143], v[32:35], v[76:79], v[140:143]
    s_waitcnt lgkmcnt(12)
    v_mfma_f32_16x16x32_bf16 v[192:195], v[48:51], v[64:67], v[192:195]
    ds_read_b64_tr_b16 v[32:33], v12 offset:36864
    v_mfma_f32_16x16x32_bf16 v[196:199], v[48:51], v[68:71], v[196:199]
    buffer_load_dwordx4 v[116:119], v11, s[24:27], s54 offen offset:2304
    v_mfma_f32_16x16x32_bf16 v[200:203], v[48:51], v[72:75], v[200:203]
    ds_read_b64_tr_b16 v[34:35], v12 offset:37376
    v_mfma_f32_16x16x32_bf16 v[204:207], v[48:51], v[76:79], v[204:207]
    s_waitcnt lgkmcnt(12)
    v_mfma_f32_16x16x32_bf16 v[144:147], v[36:39], v[64:67], v[144:147]
    ds_read_b64_tr_b16 v[48:49], v12 offset:45056
    v_mfma_f32_16x16x32_bf16 v[148:151], v[36:39], v[68:71], v[148:151]
    buffer_load_dwordx4 v[120:123], v11, s[24:27], s55 offen offset:2048
    v_mfma_f32_16x16x32_bf16 v[152:155], v[36:39], v[72:75], v[152:155]
    ds_read_b64_tr_b16 v[50:51], v12 offset:45568
    v_mfma_f32_16x16x32_bf16 v[156:159], v[36:39], v[76:79], v[156:159]
    s_waitcnt lgkmcnt(12)
    v_mfma_f32_16x16x32_bf16 v[208:211], v[52:55], v[64:67], v[208:211]
    ds_read_b64_tr_b16 v[36:37], v13 offset:36864
    v_mfma_f32_16x16x32_bf16 v[212:215], v[52:55], v[68:71], v[212:215]
    buffer_load_dwordx4 v[124:127], v11, s[24:27], s55 offen offset:2304
    v_mfma_f32_16x16x32_bf16 v[216:219], v[52:55], v[72:75], v[216:219]
    ds_read_b64_tr_b16 v[38:39], v13 offset:37376
    v_mfma_f32_16x16x32_bf16 v[220:223], v[52:55], v[76:79], v[220:223]
    s_waitcnt lgkmcnt(12)
    v_mfma_f32_16x16x32_bf16 v[160:163], v[40:43], v[64:67], v[160:163]
    ds_read_b64_tr_b16 v[52:53], v13 offset:45056
    v_mfma_f32_16x16x32_bf16 v[164:167], v[40:43], v[68:71], v[164:167]
    s_add_u32 s52, s50, 129024
    s_add_u32 m0, s51, 4096
    s_nop 0
    buffer_load_dwordx4 v2, s[12:15], s52 offen lds
    v_mfma_f32_16x16x32_bf16 v[168:171], v[40:43], v[72:75], v[168:171]
    ds_read_b64_tr_b16 v[54:55], v13 offset:45568
    v_mfma_f32_16x16x32_bf16 v[172:175], v[40:43], v[76:79], v[172:175]
    s_waitcnt lgkmcnt(12)
    v_mfma_f32_16x16x32_bf16 v[224:227], v[56:59], v[64:67], v[224:227]
    ds_read_b64_tr_b16 v[40:41], v14 offset:36864
    v_mfma_f32_16x16x32_bf16 v[228:231], v[56:59], v[68:71], v[228:231]
    v_mfma_f32_16x16x32_bf16 v[232:235], v[56:59], v[72:75], v[232:235]
    ds_read_b64_tr_b16 v[42:43], v14 offset:37376
    v_mfma_f32_16x16x32_bf16 v[236:239], v[56:59], v[76:79], v[236:239]
    s_waitcnt lgkmcnt(12)
    v_mfma_f32_16x16x32_bf16 v[176:179], v[44:47], v[64:67], v[176:179]
    ds_read_b64_tr_b16 v[56:57], v14 offset:45056
    v_mfma_f32_16x16x32_bf16 v[180:183], v[44:47], v[68:71], v[180:183]
    s_add_u32 s52, s50, 129024
    s_add_u32 m0, s51, 12288
    s_nop 0
    buffer_load_dwordx4 v2, s[16:19], s52 offen lds
    v_mfma_f32_16x16x32_bf16 v[184:187], v[44:47], v[72:75], v[184:187]
    ds_read_b64_tr_b16 v[58:59], v14 offset:45568
    v_mfma_f32_16x16x32_bf16 v[188:191], v[44:47], v[76:79], v[188:191]
    s_waitcnt lgkmcnt(12)
    v_mfma_f32_16x16x32_bf16 v[240:243], v[60:63], v[64:67], v[240:243]
    ds_read_b64_tr_b16 v[44:45], v15 offset:36864
    v_mfma_f32_16x16x32_bf16 v[244:247], v[60:63], v[68:71], v[244:247]
    v_mfma_f32_16x16x32_bf16 v[248:251], v[60:63], v[72:75], v[248:251]
    ds_read_b64_tr_b16 v[46:47], v15 offset:37376
    v_mfma_f32_16x16x32_bf16 v[252:255], v[60:63], v[76:79], v[252:255]
    s_waitcnt vmcnt(12)
    s_barrier
    s_waitcnt lgkmcnt(12)
    v_mfma_f32_16x16x32_bf16 v[128:131], v[32:35], v[80:83], v[128:131]
    ds_read_b64_tr_b16 v[60:61], v15 offset:45056
    v_mfma_f32_16x16x32_bf16 v[132:135], v[32:35], v[84:87], v[132:135]
    s_add_u32 s54, s48, 16384
    buffer_load_dwordx4 v[64:67], v11, s[24:27], s54 offen offset:0
    v_mfma_f32_16x16x32_bf16 v[136:139], v[32:35], v[88:91], v[136:139]
    ds_read_b64_tr_b16 v[62:63], v15 offset:45568
    v_mfma_f32_16x16x32_bf16 v[140:143], v[32:35], v[92:95], v[140:143]
    s_waitcnt lgkmcnt(12)
    v_mfma_f32_16x16x32_bf16 v[192:195], v[48:51], v[80:83], v[192:195]
    ds_read_b64_tr_b16 v[32:33], v12 offset:49152
    v_mfma_f32_16x16x32_bf16 v[196:199], v[48:51], v[84:87], v[196:199]
    buffer_load_dwordx4 v[68:71], v11, s[24:27], s54 offen offset:256
    v_mfma_f32_16x16x32_bf16 v[200:203], v[48:51], v[88:91], v[200:203]
    ds_read_b64_tr_b16 v[34:35], v12 offset:49664
    v_mfma_f32_16x16x32_bf16 v[204:207], v[48:51], v[92:95], v[204:207]
    s_waitcnt lgkmcnt(12)
    v_mfma_f32_16x16x32_bf16 v[144:147], v[36:39], v[80:83], v[144:147]
    ds_read_b64_tr_b16 v[48:49], v12 offset:57344
    v_mfma_f32_16x16x32_bf16 v[148:151], v[36:39], v[84:87], v[148:151]
    s_add_u32 s55, s49, 16384
    buffer_load_dwordx4 v[72:75], v11, s[24:27], s55 offen offset:0
    v_mfma_f32_16x16x32_bf16 v[152:155], v[36:39], v[88:91], v[152:155]
    ds_read_b64_tr_b16 v[50:51], v12 offset:57856
    v_mfma_f32_16x16x32_bf16 v[156:159], v[36:39], v[92:95], v[156:159]
    s_waitcnt lgkmcnt(12)
    v_mfma_f32_16x16x32_bf16 v[208:211], v[52:55], v[80:83], v[208:211]
    ds_read_b64_tr_b16 v[36:37], v13 offset:49152
    v_mfma_f32_16x16x32_bf16 v[212:215], v[52:55], v[84:87], v[212:215]
    buffer_load_dwordx4 v[76:79], v11, s[24:27], s55 offen offset:256
    v_mfma_f32_16x16x32_bf16 v[216:219], v[52:55], v[88:91], v[216:219]
    ds_read_b64_tr_b16 v[38:39], v13 offset:49664
    v_mfma_f32_16x16x32_bf16 v[220:223], v[52:55], v[92:95], v[220:223]
    s_waitcnt lgkmcnt(12)
    v_mfma_f32_16x16x32_bf16 v[160:163], v[40:43], v[80:83], v[160:163]
    ds_read_b64_tr_b16 v[52:53], v13 offset:57344
    v_mfma_f32_16x16x32_bf16 v[164:167], v[40:43], v[84:87], v[164:167]
    s_add_u32 s52, s50, 143360
    s_add_u32 m0, s51, 16384
    s_nop 0
    buffer_load_dwordx4 v2, s[12:15], s52 offen lds
    v_mfma_f32_16x16x32_bf16 v[168:171], v[40:43], v[88:91], v[168:171]
    ds_read_b64_tr_b16 v[54:55], v13 offset:57856
    v_mfma_f32_16x16x32_bf16 v[172:175], v[40:43], v[92:95], v[172:175]
    s_waitcnt lgkmcnt(12)
    v_mfma_f32_16x16x32_bf16 v[224:227], v[56:59], v[80:83], v[224:227]
    ds_read_b64_tr_b16 v[40:41], v14 offset:49152
    v_mfma_f32_16x16x32_bf16 v[228:231], v[56:59], v[84:87], v[228:231]
    s_add_u32 s57, s56, 0
    buffer_load_dword v19, v18, s[20:23], s57 offen
    v_mfma_f32_16x16x32_bf16 v[232:235], v[56:59], v[88:91], v[232:235]
    ds_read_b64_tr_b16 v[42:43], v14 offset:49664
    v_mfma_f32_16x16x32_bf16 v[236:239], v[56:59], v[92:95], v[236:239]
    s_waitcnt lgkmcnt(12)
    v_mfma_f32_16x16x32_bf16 v[176:179], v[44:47], v[80:83], v[176:179]
    ds_read_b64_tr_b16 v[56:57], v14 offset:57344
    v_mfma_f32_16x16x32_bf16 v[180:183], v[44:47], v[84:87], v[180:183]
    s_add_u32 s52, s50, 143360
    s_add_u32 m0, s51, 24576
    s_nop 0
    buffer_load_dwordx4 v2, s[16:19], s52 offen lds
    v_mfma_f32_16x16x32_bf16 v[184:187], v[44:47], v[88:91], v[184:187]
    ds_read_b64_tr_b16 v[58:59], v14 offset:57856
    v_mfma_f32_16x16x32_bf16 v[188:191], v[44:47], v[92:95], v[188:191]
    s_waitcnt lgkmcnt(12)
    v_mfma_f32_16x16x32_bf16 v[240:243], v[60:63], v[80:83], v[240:243]
    ds_read_b64_tr_b16 v[44:45], v15 offset:49152
    v_mfma_f32_16x16x32_bf16 v[244:247], v[60:63], v[84:87], v[244:247]
    s_add_u32 s57, s56, 4096
    buffer_load_dword v19, v18, s[20:23], s57 offen
    v_mfma_f32_16x16x32_bf16 v[248:251], v[60:63], v[88:91], v[248:251]
    ds_read_b64_tr_b16 v[46:47], v15 offset:49664
    v_mfma_f32_16x16x32_bf16 v[252:255], v[60:63], v[92:95], v[252:255]
    s_waitcnt vmcnt(16)
    s_waitcnt lgkmcnt(12)
    v_mfma_f32_16x16x32_bf16 v[128:131], v[32:35], v[96:99], v[128:131]
    ds_read_b64_tr_b16 v[60:61], v15 offset:57344
    v_mfma_f32_16x16x32_bf16 v[132:135], v[32:35], v[100:103], v[132:135]
    buffer_load_dwordx4 v[80:83], v11, s[24:27], s54 offen offset:2048
    v_mfma_f32_16x16x32_bf16 v[136:139], v[32:35], v[104:107], v[136:139]
    ds_read_b64_tr_b16 v[62:63], v15 offset:57856
    v_mfma_f32_16x16x32_bf16 v[140:143], v[32:35], v[108:111], v[140:143]
    s_waitcnt lgkmcnt(12)
    v_mfma_f32_16x16x32_bf16 v[192:195], v[48:51], v[96:99], v[192:195]
    ds_read_b64_tr_b16 v[32:33], v12 offset:53248
    v_mfma_f32_16x16x32_bf16 v[196:199], v[48:51], v[100:103], v[196:199]
    buffer_load_dwordx4 v[84:87], v11, s[24:27], s54 offen offset:2304
    v_mfma_f32_16x16x32_bf16 v[200:203], v[48:51], v[104:107], v[200:203]
    ds_read_b64_tr_b16 v[34:35], v12 offset:53760
    v_mfma_f32_16x16x32_bf16 v[204:207], v[48:51], v[108:111], v[204:207]
    s_waitcnt lgkmcnt(12)
    v_mfma_f32_16x16x32_bf16 v[144:147], v[36:39], v[96:99], v[144:147]
    ds_read_b64_tr_b16 v[48:49], v12 offset:61440
    v_mfma_f32_16x16x32_bf16 v[148:151], v[36:39], v[100:103], v[148:151]
    buffer_load_dwordx4 v[88:91], v11, s[24:27], s55 offen offset:2048
    v_mfma_f32_16x16x32_bf16 v[152:155], v[36:39], v[104:107], v[152:155]
    ds_read_b64_tr_b16 v[50:51], v12 offset:61952
    v_mfma_f32_16x16x32_bf16 v[156:159], v[36:39], v[108:111], v[156:159]
    s_waitcnt lgkmcnt(12)
    v_mfma_f32_16x16x32_bf16 v[208:211], v[52:55], v[96:99], v[208:211]
    ds_read_b64_tr_b16 v[36:37], v13 offset:53248
    v_mfma_f32_16x16x32_bf16 v[212:215], v[52:55], v[100:103], v[212:215]
    buffer_load_dwordx4 v[92:95], v11, s[24:27], s55 offen offset:2304
    v_mfma_f32_16x16x32_bf16 v[216:219], v[52:55], v[104:107], v[216:219]
    ds_read_b64_tr_b16 v[38:39], v13 offset:53760
    v_mfma_f32_16x16x32_bf16 v[220:223], v[52:55], v[108:111], v[220:223]
    s_waitcnt lgkmcnt(12)
    v_mfma_f32_16x16x32_bf16 v[160:163], v[40:43], v[96:99], v[160:163]
    ds_read_b64_tr_b16 v[52:53], v13 offset:61440
    v_mfma_f32_16x16x32_bf16 v[164:167], v[40:43], v[100:103], v[164:167]
    s_add_u32 s52, s50, 157696
    s_add_u32 m0, s51, 20480
    s_nop 0
    buffer_load_dwordx4 v2, s[12:15], s52 offen lds
    v_mfma_f32_16x16x32_bf16 v[168:171], v[40:43], v[104:107], v[168:171]
    ds_read_b64_tr_b16 v[54:55], v13 offset:61952
    v_mfma_f32_16x16x32_bf16 v[172:175], v[40:43], v[108:111], v[172:175]
    s_waitcnt lgkmcnt(12)
    v_mfma_f32_16x16x32_bf16 v[224:227], v[56:59], v[96:99], v[224:227]
    ds_read_b64_tr_b16 v[40:41], v14 offset:53248
    v_mfma_f32_16x16x32_bf16 v[228:231], v[56:59], v[100:103], v[228:231]
    s_add_u32 s57, s56, 8192
    buffer_load_dword v19, v18, s[20:23], s57 offen
    v_mfma_f32_16x16x32_bf16 v[232:235], v[56:59], v[104:107], v[232:235]
    ds_read_b64_tr_b16 v[42:43], v14 offset:53760
    v_mfma_f32_16x16x32_bf16 v[236:239], v[56:59], v[108:111], v[236:239]
    s_waitcnt lgkmcnt(12)
    v_mfma_f32_16x16x32_bf16 v[176:179], v[44:47], v[96:99], v[176:179]
    ds_read_b64_tr_b16 v[56:57], v14 offset:61440
    v_mfma_f32_16x16x32_bf16 v[180:183], v[44:47], v[100:103], v[180:183]
    s_add_u32 s52, s50, 157696
    s_add_u32 m0, s51, 28672
    s_nop 0
    buffer_load_dwordx4 v2, s[16:19], s52 offen lds
    v_mfma_f32_16x16x32_bf16 v[184:187], v[44:47], v[104:107], v[184:187]
    ds_read_b64_tr_b16 v[58:59], v14 offset:61952
    v_mfma_f32_16x16x32_bf16 v[188:191], v[44:47], v[108:111], v[188:191]
    s_waitcnt lgkmcnt(12)
    v_mfma_f32_16x16x32_bf16 v[240:243], v[60:63], v[96:99], v[240:243]
    ds_read_b64_tr_b16 v[44:45], v15 offset:53248
    v_mfma_f32_16x16x32_bf16 v[244:247], v[60:63], v[100:103], v[244:247]
    s_add_u32 s57, s56, 12288
    buffer_load_dword v19, v18, s[20:23], s57 offen
    v_mfma_f32_16x16x32_bf16 v[248:251], v[60:63], v[104:107], v[248:251]
    ds_read_b64_tr_b16 v[46:47], v15 offset:53760
    v_mfma_f32_16x16x32_bf16 v[252:255], v[60:63], v[108:111], v[252:255]
    s_waitcnt vmcnt(16)
    s_barrier
    s_waitcnt lgkmcnt(12)
    v_mfma_f32_16x16x32_bf16 v[128:131], v[32:35], v[112:115], v[128:131]
    ds_read_b64_tr_b16 v[60:61], v15 offset:61440
    v_mfma_f32_16x16x32_bf16 v[132:135], v[32:35], v[116:119], v[132:135]
    s_add_u32 s54, s48, 20480
    buffer_load_dwordx4 v[96:99], v11, s[24:27], s54 offen offset:0
    v_mfma_f32_16x16x32_bf16 v[136:139], v[32:35], v[120:123], v[136:139]
    ds_read_b64_tr_b16 v[62:63], v15 offset:61952
    v_mfma_f32_16x16x32_bf16 v[140:143], v[32:35], v[124:127], v[140:143]
    s_waitcnt lgkmcnt(12)
    v_mfma_f32_16x16x32_bf16 v[192:195], v[48:51], v[112:115], v[192:195]
    ds_read_b64_tr_b16 v[32:33], v12 offset:0
    v_mfma_f32_16x16x32_bf16 v[196:199], v[48:51], v[116:119], v[196:199]
    buffer_load_dwordx4 v[100:103], v11, s[24:27], s54 offen offset:256
    v_mfma_f32_16x16x32_bf16 v[200:203], v[48:51], v[120:123], v[200:203]
    ds_read_b64_tr_b16 v[34:35], v12 offset:512
    v_mfma_f32_16x16x32_bf16 v[204:207], v[48:51], v[124:127], v[204:207]
    s_waitcnt lgkmcnt(12)
    v_mfma_f32_16x16x32_bf16 v[144:147], v[36:39], v[112:115], v[144:147]
    ds_read_b64_tr_b16 v[48:49], v12 offset:8192
    v_mfma_f32_16x16x32_bf16 v[148:151], v[36:39], v[116:119], v[148:151]
    s_add_u32 s55, s49, 20480
    buffer_load_dwordx4 v[104:107], v11, s[24:27], s55 offen offset:0
    v_mfma_f32_16x16x32_bf16 v[152:155], v[36:39], v[120:123], v[152:155]
    ds_read_b64_tr_b16 v[50:51], v12 offset:8704
    v_mfma_f32_16x16x32_bf16 v[156:159], v[36:39], v[124:127], v[156:159]
    s_waitcnt lgkmcnt(12)
    v_mfma_f32_16x16x32_bf16 v[208:211], v[52:55], v[112:115], v[208:211]
    ds_read_b64_tr_b16 v[36:37], v13 offset:0
    v_mfma_f32_16x16x32_bf16 v[212:215], v[52:55], v[116:119], v[212:215]
    buffer_load_dwordx4 v[108:111], v11, s[24:27], s55 offen offset:256
    v_mfma_f32_16x16x32_bf16 v[216:219], v[52:55], v[120:123], v[216:219]
    ds_read_b64_tr_b16 v[38:39], v13 offset:512
    v_mfma_f32_16x16x32_bf16 v[220:223], v[52:55], v[124:127], v[220:223]
    s_waitcnt lgkmcnt(12)
    v_mfma_f32_16x16x32_bf16 v[160:163], v[40:43], v[112:115], v[160:163]
    ds_read_b64_tr_b16 v[52:53], v13 offset:8192
    v_mfma_f32_16x16x32_bf16 v[164:167], v[40:43], v[116:119], v[164:167]
    s_add_u32 s52, s50, 172032
    s_add_u32 m0, s51, 32768
    s_nop 0
    buffer_load_dwordx4 v2, s[12:15], s52 offen lds
    v_mfma_f32_16x16x32_bf16 v[168:171], v[40:43], v[120:123], v[168:171]
    ds_read_b64_tr_b16 v[54:55], v13 offset:8704
    v_mfma_f32_16x16x32_bf16 v[172:175], v[40:43], v[124:127], v[172:175]
    s_waitcnt lgkmcnt(12)
    v_mfma_f32_16x16x32_bf16 v[224:227], v[56:59], v[112:115], v[224:227]
    ds_read_b64_tr_b16 v[40:41], v14 offset:0
    v_mfma_f32_16x16x32_bf16 v[228:231], v[56:59], v[116:119], v[228:231]
    s_add_u32 s57, s56, 16384
    buffer_load_dword v19, v18, s[20:23], s57 offen
    v_mfma_f32_16x16x32_bf16 v[232:235], v[56:59], v[120:123], v[232:235]
    ds_read_b64_tr_b16 v[42:43], v14 offset:512
    v_mfma_f32_16x16x32_bf16 v[236:239], v[56:59], v[124:127], v[236:239]
    s_waitcnt lgkmcnt(12)
    v_mfma_f32_16x16x32_bf16 v[176:179], v[44:47], v[112:115], v[176:179]
    ds_read_b64_tr_b16 v[56:57], v14 offset:8192
    v_mfma_f32_16x16x32_bf16 v[180:183], v[44:47], v[116:119], v[180:183]
    s_add_u32 s52, s50, 172032
    s_add_u32 m0, s51, 40960
    s_nop 0
    buffer_load_dwordx4 v2, s[16:19], s52 offen lds
    v_mfma_f32_16x16x32_bf16 v[184:187], v[44:47], v[120:123], v[184:187]
    ds_read_b64_tr_b16 v[58:59], v14 offset:8704
    v_mfma_f32_16x16x32_bf16 v[188:191], v[44:47], v[124:127], v[188:191]
    s_waitcnt lgkmcnt(12)
    v_mfma_f32_16x16x32_bf16 v[240:243], v[60:63], v[112:115], v[240:243]
    ds_read_b64_tr_b16 v[44:45], v15 offset:0
    v_mfma_f32_16x16x32_bf16 v[244:247], v[60:63], v[116:119], v[244:247]
    s_add_u32 s57, s56, 20480
    buffer_load_dword v19, v18, s[20:23], s57 offen
    v_mfma_f32_16x16x32_bf16 v[248:251], v[60:63], v[120:123], v[248:251]
    ds_read_b64_tr_b16 v[46:47], v15 offset:512
    v_mfma_f32_16x16x32_bf16 v[252:255], v[60:63], v[124:127], v[252:255]
    s_waitcnt vmcnt(20)
    s_waitcnt lgkmcnt(12)
    v_mfma_f32_16x16x32_bf16 v[128:131], v[32:35], v[64:67], v[128:131]
    ds_read_b64_tr_b16 v[60:61], v15 offset:8192
    v_mfma_f32_16x16x32_bf16 v[132:135], v[32:35], v[68:71], v[132:135]
    buffer_load_dwordx4 v[112:115], v11, s[24:27], s54 offen offset:2048
    v_mfma_f32_16x16x32_bf16 v[136:139], v[32:35], v[72:75], v[136:139]
    ds_read_b64_tr_b16 v[62:63], v15 offset:8704
    v_mfma_f32_16x16x32_bf16 v[140:143], v[32:35], v[76:79], v[140:143]
    s_waitcnt lgkmcnt(12)
    v_mfma_f32_16x16x32_bf16 v[192:195], v[48:51], v[64:67], v[192:195]
    ds_read_b64_tr_b16 v[32:33], v12 offset:4096
    v_mfma_f32_16x16x32_bf16 v[196:199], v[48:51], v[68:71], v[196:199]
    buffer_load_dwordx4 v[116:119], v11, s[24:27], s54 offen offset:2304
    v_mfma_f32_16x16x32_bf16 v[200:203], v[48:51], v[72:75], v[200:203]
    ds_read_b64_tr_b16 v[34:35], v12 offset:4608
    v_mfma_f32_16x16x32_bf16 v[204:207], v[48:51], v[76:79], v[204:207]
    s_waitcnt lgkmcnt(12)
    v_mfma_f32_16x16x32_bf16 v[144:147], v[36:39], v[64:67], v[144:147]
    ds_read_b64_tr_b16 v[48:49], v12 offset:12288
    v_mfma_f32_16x16x32_bf16 v[148:151], v[36:39], v[68:71], v[148:151]
    buffer_load_dwordx4 v[120:123], v11, s[24:27], s55 offen offset:2048
    v_mfma_f32_16x16x32_bf16 v[152:155], v[36:39], v[72:75], v[152:155]
    ds_read_b64_tr_b16 v[50:51], v12 offset:12800
    v_mfma_f32_16x16x32_bf16 v[156:159], v[36:39], v[76:79], v[156:159]
    s_waitcnt lgkmcnt(12)
    v_mfma_f32_16x16x32_bf16 v[208:211], v[52:55], v[64:67], v[208:211]
    ds_read_b64_tr_b16 v[36:37], v13 offset:4096
    v_mfma_f32_16x16x32_bf16 v[212:215], v[52:55], v[68:71], v[212:215]
    buffer_load_dwordx4 v[124:127], v11, s[24:27], s55 offen offset:2304
    v_mfma_f32_16x16x32_bf16 v[216:219], v[52:55], v[72:75], v[216:219]
    ds_read_b64_tr_b16 v[38:39], v13 offset:4608
    v_mfma_f32_16x16x32_bf16 v[220:223], v[52:55], v[76:79], v[220:223]
    s_waitcnt lgkmcnt(12)
    v_mfma_f32_16x16x32_bf16 v[160:163], v[40:43], v[64:67], v[160:163]
    ds_read_b64_tr_b16 v[52:53], v13 offset:12288
    v_mfma_f32_16x16x32_bf16 v[164:167], v[40:43], v[68:71], v[164:167]
    s_add_u32 s52, s50, 186368
    s_add_u32 m0, s51, 36864
    s_nop 0
    buffer_load_dwordx4 v2, s[12:15], s52 offen lds
    v_mfma_f32_16x16x32_bf16 v[168:171], v[40:43], v[72:75], v[168:171]
    ds_read_b64_tr_b16 v[54:55], v13 offset:12800
    v_mfma_f32_16x16x32_bf16 v[172:175], v[40:43], v[76:79], v[172:175]
    s_waitcnt lgkmcnt(12)
    v_mfma_f32_16x16x32_bf16 v[224:227], v[56:59], v[64:67], v[224:227]
    ds_read_b64_tr_b16 v[40:41], v14 offset:4096
    v_mfma_f32_16x16x32_bf16 v[228:231], v[56:59], v[68:71], v[228:231]
    s_add_u32 s57, s56, 24576
    buffer_load_dword v19, v18, s[20:23], s57 offen
    v_mfma_f32_16x16x32_bf16 v[232:235], v[56:59], v[72:75], v[232:235]
    ds_read_b64_tr_b16 v[42:43], v14 offset:4608
    v_mfma_f32_16x16x32_bf16 v[236:239], v[56:59], v[76:79], v[236:239]
    s_waitcnt lgkmcnt(12)
    v_mfma_f32_16x16x32_bf16 v[176:179], v[44:47], v[64:67], v[176:179]
    ds_read_b64_tr_b16 v[56:57], v14 offset:12288
    v_mfma_f32_16x16x32_bf16 v[180:183], v[44:47], v[68:71], v[180:183]
    s_add_u32 s52, s50, 186368
    s_add_u32 m0, s51, 45056
    s_nop 0
    buffer_load_dwordx4 v2, s[16:19], s52 offen lds
    v_mfma_f32_16x16x32_bf16 v[184:187], v[44:47], v[72:75], v[184:187]
    ds_read_b64_tr_b16 v[58:59], v14 offset:12800
    v_mfma_f32_16x16x32_bf16 v[188:191], v[44:47], v[76:79], v[188:191]
    s_waitcnt lgkmcnt(12)
    v_mfma_f32_16x16x32_bf16 v[240:243], v[60:63], v[64:67], v[240:243]
    ds_read_b64_tr_b16 v[44:45], v15 offset:4096
    v_mfma_f32_16x16x32_bf16 v[244:247], v[60:63], v[68:71], v[244:247]
    s_add_u32 s57, s56, 28672
    buffer_load_dword v19, v18, s[20:23], s57 offen
    v_mfma_f32_16x16x32_bf16 v[248:251], v[60:63], v[72:75], v[248:251]
    ds_read_b64_tr_b16 v[46:47], v15 offset:4608
    v_mfma_f32_16x16x32_bf16 v[252:255], v[60:63], v[76:79], v[252:255]
    s_waitcnt vmcnt(17)
    s_barrier
    s_waitcnt lgkmcnt(12)
    v_mfma_f32_16x16x32_bf16 v[128:131], v[32:35], v[80:83], v[128:131]
    ds_read_b64_tr_b16 v[60:61], v15 offset:12288
    v_mfma_f32_16x16x32_bf16 v[132:135], v[32:35], v[84:87], v[132:135]
    s_add_u32 s54, s48, 24576
    buffer_load_dwordx4 v[64:67], v11, s[24:27], s54 offen offset:0
    v_mfma_f32_16x16x32_bf16 v[136:139], v[32:35], v[88:91], v[136:139]
    ds_read_b64_tr_b16 v[62:63], v15 offset:12800
    v_mfma_f32_16x16x32_bf16 v[140:143], v[32:35], v[92:95], v[140:143]
    s_waitcnt lgkmcnt(12)
    v_mfma_f32_16x16x32_bf16 v[192:195], v[48:51], v[80:83], v[192:195]
    ds_read_b64_tr_b16 v[32:33], v12 offset:16384
    v_mfma_f32_16x16x32_bf16 v[196:199], v[48:51], v[84:87], v[196:199]
    buffer_load_dwordx4 v[68:71], v11, s[24:27], s54 offen offset:256
    v_mfma_f32_16x16x32_bf16 v[200:203], v[48:51], v[88:91], v[200:203]
    ds_read_b64_tr_b16 v[34:35], v12 offset:16896
    v_mfma_f32_16x16x32_bf16 v[204:207], v[48:51], v[92:95], v[204:207]
    s_waitcnt lgkmcnt(12)
    v_mfma_f32_16x16x32_bf16 v[144:147], v[36:39], v[80:83], v[144:147]
    ds_read_b64_tr_b16 v[48:49], v12 offset:24576
    v_mfma_f32_16x16x32_bf16 v[148:151], v[36:39], v[84:87], v[148:151]
    s_add_u32 s55, s49, 24576
    buffer_load_dwordx4 v[72:75], v11, s[24:27], s55 offen offset:0
    v_mfma_f32_16x16x32_bf16 v[152:155], v[36:39], v[88:91], v[152:155]
    ds_read_b64_tr_b16 v[50:51], v12 offset:25088
    v_mfma_f32_16x16x32_bf16 v[156:159], v[36:39], v[92:95], v[156:159]
    s_waitcnt lgkmcnt(12)
    v_mfma_f32_16x16x32_bf16 v[208:211], v[52:55], v[80:83], v[208:211]
    ds_read_b64_tr_b16 v[36:37], v13 offset:16384
    v_mfma_f32_16x16x32_bf16 v[212:215], v[52:55], v[84:87], v[212:215]
    buffer_load_dwordx4 v[76:79], v11, s[24:27], s55 offen offset:256
    v_mfma_f32_16x16x32_bf16 v[216:219], v[52:55], v[88:91], v[216:219]
    ds_read_b64_tr_b16 v[38:39], v13 offset:16896
    v_mfma_f32_16x16x32_bf16 v[220:223], v[52:55], v[92:95], v[220:223]
    s_waitcnt lgkmcnt(12)
    v_mfma_f32_16x16x32_bf16 v[160:163], v[40:43], v[80:83], v[160:163]
    ds_read_b64_tr_b16 v[52:53], v13 offset:24576
    v_mfma_f32_16x16x32_bf16 v[164:167], v[40:43], v[84:87], v[164:167]
    s_add_u32 s52, s50, 200704
    s_add_u32 m0, s51, 49152
    s_nop 0
    buffer_load_dwordx4 v2, s[12:15], s52 offen lds
    v_mfma_f32_16x16x32_bf16 v[168:171], v[40:43], v[88:91], v[168:171]
    ds_read_b64_tr_b16 v[54:55], v13 offset:25088
    v_mfma_f32_16x16x32_bf16 v[172:175], v[40:43], v[92:95], v[172:175]
    s_waitcnt lgkmcnt(12)
    v_mfma_f32_16x16x32_bf16 v[224:227], v[56:59], v[80:83], v[224:227]
    ds_read_b64_tr_b16 v[40:41], v14 offset:16384
    v_mfma_f32_16x16x32_bf16 v[228:231], v[56:59], v[84:87], v[228:231]
    s_add_u32 s57, s56, 32768
    buffer_load_dword v19, v18, s[20:23], s57 offen
    v_mfma_f32_16x16x32_bf16 v[232:235], v[56:59], v[88:91], v[232:235]
    ds_read_b64_tr_b16 v[42:43], v14 offset:16896
    v_mfma_f32_16x16x32_bf16 v[236:239], v[56:59], v[92:95], v[236:239]
    s_waitcnt lgkmcnt(12)
    v_mfma_f32_16x16x32_bf16 v[176:179], v[44:47], v[80:83], v[176:179]
    ds_read_b64_tr_b16 v[56:57], v14 offset:24576
    v_mfma_f32_16x16x32_bf16 v[180:183], v[44:47], v[84:87], v[180:183]
    s_add_u32 s52, s50, 200704
    s_add_u32 m0, s51, 57344
    s_nop 0
    buffer_load_dwordx4 v2, s[16:19], s52 offen lds
    v_mfma_f32_16x16x32_bf16 v[184:187], v[44:47], v[88:91], v[184:187]
    ds_read_b64_tr_b16 v[58:59], v14 offset:25088
    v_mfma_f32_16x16x32_bf16 v[188:191], v[44:47], v[92:95], v[188:191]
    s_waitcnt lgkmcnt(12)
    v_mfma_f32_16x16x32_bf16 v[240:243], v[60:63], v[80:83], v[240:243]
    ds_read_b64_tr_b16 v[44:45], v15 offset:16384
    v_mfma_f32_16x16x32_bf16 v[244:247], v[60:63], v[84:87], v[244:247]
    s_add_u32 s57, s56, 36864
    buffer_load_dword v19, v18, s[20:23], s57 offen
    v_mfma_f32_16x16x32_bf16 v[248:251], v[60:63], v[88:91], v[248:251]
    ds_read_b64_tr_b16 v[46:47], v15 offset:16896
    v_mfma_f32_16x16x32_bf16 v[252:255], v[60:63], v[92:95], v[252:255]
    s_waitcnt vmcnt(20)
    s_waitcnt lgkmcnt(12)
    v_mfma_f32_16x16x32_bf16 v[128:131], v[32:35], v[96:99], v[128:131]
    ds_read_b64_tr_b16 v[60:61], v15 offset:24576
    v_mfma_f32_16x16x32_bf16 v[132:135], v[32:35], v[100:103], v[132:135]
    buffer_load_dwordx4 v[80:83], v11, s[24:27], s54 offen offset:2048
    v_mfma_f32_16x16x32_bf16 v[136:139], v[32:35], v[104:107], v[136:139]
    ds_read_b64_tr_b16 v[62:63], v15 offset:25088
    v_mfma_f32_16x16x32_bf16 v[140:143], v[32:35], v[108:111], v[140:143]
    s_waitcnt lgkmcnt(12)
    v_mfma_f32_16x16x32_bf16 v[192:195], v[48:51], v[96:99], v[192:195]
    ds_read_b64_tr_b16 v[32:33], v12 offset:20480
    v_mfma_f32_16x16x32_bf16 v[196:199], v[48:51], v[100:103], v[196:199]
    buffer_load_dwordx4 v[84:87], v11, s[24:27], s54 offen offset:2304
    v_mfma_f32_16x16x32_bf16 v[200:203], v[48:51], v[104:107], v[200:203]
    ds_read_b64_tr_b16 v[34:35], v12 offset:20992
    v_mfma_f32_16x16x32_bf16 v[204:207], v[48:51], v[108:111], v[204:207]
    s_waitcnt lgkmcnt(12)
    v_mfma_f32_16x16x32_bf16 v[144:147], v[36:39], v[96:99], v[144:147]
    ds_read_b64_tr_b16 v[48:49], v12 offset:28672
    v_mfma_f32_16x16x32_bf16 v[148:151], v[36:39], v[100:103], v[148:151]
    buffer_load_dwordx4 v[88:91], v11, s[24:27], s55 offen offset:2048
    v_mfma_f32_16x16x32_bf16 v[152:155], v[36:39], v[104:107], v[152:155]
    ds_read_b64_tr_b16 v[50:51], v12 offset:29184
    v_mfma_f32_16x16x32_bf16 v[156:159], v[36:39], v[108:111], v[156:159]
    s_waitcnt lgkmcnt(12)
    v_mfma_f32_16x16x32_bf16 v[208:211], v[52:55], v[96:99], v[208:211]
    ds_read_b64_tr_b16 v[36:37], v13 offset:20480
    v_mfma_f32_16x16x32_bf16 v[212:215], v[52:55], v[100:103], v[212:215]
    buffer_load_dwordx4 v[92:95], v11, s[24:27], s55 offen offset:2304
    v_mfma_f32_16x16x32_bf16 v[216:219], v[52:55], v[104:107], v[216:219]
    ds_read_b64_tr_b16 v[38:39], v13 offset:20992
    v_mfma_f32_16x16x32_bf16 v[220:223], v[52:55], v[108:111], v[220:223]
    s_waitcnt lgkmcnt(12)
    v_mfma_f32_16x16x32_bf16 v[160:163], v[40:43], v[96:99], v[160:163]
    ds_read_b64_tr_b16 v[52:53], v13 offset:28672
    v_mfma_f32_16x16x32_bf16 v[164:167], v[40:43], v[100:103], v[164:167]
    s_add_u32 s52, s50, 215040
    s_add_u32 m0, s51, 53248
    s_nop 0
    buffer_load_dwordx4 v2, s[12:15], s52 offen lds
    v_mfma_f32_16x16x32_bf16 v[168:171], v[40:43], v[104:107], v[168:171]
    ds_read_b64_tr_b16 v[54:55], v13 offset:29184
    v_mfma_f32_16x16x32_bf16 v[172:175], v[40:43], v[108:111], v[172:175]
    s_waitcnt lgkmcnt(12)
    v_mfma_f32_16x16x32_bf16 v[224:227], v[56:59], v[96:99], v[224:227]
    ds_read_b64_tr_b16 v[40:41], v14 offset:20480
    v_mfma_f32_16x16x32_bf16 v[228:231], v[56:59], v[100:103], v[228:231]
    s_add_u32 s57, s56, 40960
    buffer_load_dword v19, v18, s[20:23], s57 offen
    v_mfma_f32_16x16x32_bf16 v[232:235], v[56:59], v[104:107], v[232:235]
    ds_read_b64_tr_b16 v[42:43], v14 offset:20992
    v_mfma_f32_16x16x32_bf16 v[236:239], v[56:59], v[108:111], v[236:239]
    s_waitcnt lgkmcnt(12)
    v_mfma_f32_16x16x32_bf16 v[176:179], v[44:47], v[96:99], v[176:179]
    ds_read_b64_tr_b16 v[56:57], v14 offset:28672
    v_mfma_f32_16x16x32_bf16 v[180:183], v[44:47], v[100:103], v[180:183]
    s_add_u32 s52, s50, 215040
    s_add_u32 m0, s51, 61440
    s_nop 0
    buffer_load_dwordx4 v2, s[16:19], s52 offen lds
    v_mfma_f32_16x16x32_bf16 v[184:187], v[44:47], v[104:107], v[184:187]
    ds_read_b64_tr_b16 v[58:59], v14 offset:29184
    v_mfma_f32_16x16x32_bf16 v[188:191], v[44:47], v[108:111], v[188:191]
    s_waitcnt lgkmcnt(12)
    v_mfma_f32_16x16x32_bf16 v[240:243], v[60:63], v[96:99], v[240:243]
    ds_read_b64_tr_b16 v[44:45], v15 offset:20480
    v_mfma_f32_16x16x32_bf16 v[244:247], v[60:63], v[100:103], v[244:247]
    s_add_u32 s57, s56, 45056
    buffer_load_dword v19, v18, s[20:23], s57 offen
    v_mfma_f32_16x16x32_bf16 v[248:251], v[60:63], v[104:107], v[248:251]
    ds_read_b64_tr_b16 v[46:47], v15 offset:20992
    v_mfma_f32_16x16x32_bf16 v[252:255], v[60:63], v[108:111], v[252:255]
    s_waitcnt vmcnt(17)
    s_barrier
    s_waitcnt lgkmcnt(12)
    v_mfma_f32_16x16x32_bf16 v[128:131], v[32:35], v[112:115], v[128:131]
    ds_read_b64_tr_b16 v[60:61], v15 offset:28672
    v_mfma_f32_16x16x32_bf16 v[132:135], v[32:35], v[116:119], v[132:135]
    s_add_u32 s54, s48, 28672
    buffer_load_dwordx4 v[96:99], v11, s[24:27], s54 offen offset:0
    v_mfma_f32_16x16x32_bf16 v[136:139], v[32:35], v[120:123], v[136:139]
    ds_read_b64_tr_b16 v[62:63], v15 offset:29184
    v_mfma_f32_16x16x32_bf16 v[140:143], v[32:35], v[124:127], v[140:143]
    s_waitcnt lgkmcnt(12)
    v_mfma_f32_16x16x32_bf16 v[192:195], v[48:51], v[112:115], v[192:195]
    ds_read_b64_tr_b16 v[32:33], v12 offset:32768
    v_mfma_f32_16x16x32_bf16 v[196:199], v[48:51], v[116:119], v[196:199]
    buffer_load_dwordx4 v[100:103], v11, s[24:27], s54 offen offset:256
    v_mfma_f32_16x16x32_bf16 v[200:203], v[48:51], v[120:123], v[200:203]
    ds_read_b64_tr_b16 v[34:35], v12 offset:33280
    v_mfma_f32_16x16x32_bf16 v[204:207], v[48:51], v[124:127], v[204:207]
    s_waitcnt lgkmcnt(12)
    v_mfma_f32_16x16x32_bf16 v[144:147], v[36:39], v[112:115], v[144:147]
    ds_read_b64_tr_b16 v[48:49], v12 offset:40960
    v_mfma_f32_16x16x32_bf16 v[148:151], v[36:39], v[116:119], v[148:151]
    s_add_u32 s55, s49, 28672
    buffer_load_dwordx4 v[104:107], v11, s[24:27], s55 offen offset:0
    v_mfma_f32_16x16x32_bf16 v[152:155], v[36:39], v[120:123], v[152:155]
    ds_read_b64_tr_b16 v[50:51], v12 offset:41472
    v_mfma_f32_16x16x32_bf16 v[156:159], v[36:39], v[124:127], v[156:159]
    s_waitcnt lgkmcnt(12)
    v_mfma_f32_16x16x32_bf16 v[208:211], v[52:55], v[112:115], v[208:211]
    ds_read_b64_tr_b16 v[36:37], v13 offset:32768
    v_mfma_f32_16x16x32_bf16 v[212:215], v[52:55], v[116:119], v[212:215]
    buffer_load_dwordx4 v[108:111], v11, s[24:27], s55 offen offset:256
    v_mfma_f32_16x16x32_bf16 v[216:219], v[52:55], v[120:123], v[216:219]
    ds_read_b64_tr_b16 v[38:39], v13 offset:33280
    v_mfma_f32_16x16x32_bf16 v[220:223], v[52:55], v[124:127], v[220:223]
    s_waitcnt lgkmcnt(12)
    v_mfma_f32_16x16x32_bf16 v[160:163], v[40:43], v[112:115], v[160:163]
    ds_read_b64_tr_b16 v[52:53], v13 offset:40960
    v_mfma_f32_16x16x32_bf16 v[164:167], v[40:43], v[116:119], v[164:167]
    v_mfma_f32_16x16x32_bf16 v[168:171], v[40:43], v[120:123], v[168:171]
    ds_read_b64_tr_b16 v[54:55], v13 offset:41472
    v_mfma_f32_16x16x32_bf16 v[172:175], v[40:43], v[124:127], v[172:175]
    s_waitcnt lgkmcnt(12)
    v_mfma_f32_16x16x32_bf16 v[224:227], v[56:59], v[112:115], v[224:227]
    ds_read_b64_tr_b16 v[40:41], v14 offset:32768
    v_mfma_f32_16x16x32_bf16 v[228:231], v[56:59], v[116:119], v[228:231]
    s_add_u32 s57, s56, 49152
    buffer_load_dword v19, v18, s[20:23], s57 offen
    v_mfma_f32_16x16x32_bf16 v[232:235], v[56:59], v[120:123], v[232:235]
    ds_read_b64_tr_b16 v[42:43], v14 offset:33280
    v_mfma_f32_16x16x32_bf16 v[236:239], v[56:59], v[124:127], v[236:239]
    s_waitcnt lgkmcnt(12)
    v_mfma_f32_16x16x32_bf16 v[176:179], v[44:47], v[112:115], v[176:179]
    ds_read_b64_tr_b16 v[56:57], v14 offset:40960
    v_mfma_f32_16x16x32_bf16 v[180:183], v[44:47], v[116:119], v[180:183]
    v_mfma_f32_16x16x32_bf16 v[184:187], v[44:47], v[120:123], v[184:187]
    ds_read_b64_tr_b16 v[58:59], v14 offset:41472
    v_mfma_f32_16x16x32_bf16 v[188:191], v[44:47], v[124:127], v[188:191]
    s_waitcnt lgkmcnt(12)
    v_mfma_f32_16x16x32_bf16 v[240:243], v[60:63], v[112:115], v[240:243]
    ds_read_b64_tr_b16 v[44:45], v15 offset:32768
    v_mfma_f32_16x16x32_bf16 v[244:247], v[60:63], v[116:119], v[244:247]
    s_add_u32 s57, s56, 53248
    buffer_load_dword v19, v18, s[20:23], s57 offen
    v_mfma_f32_16x16x32_bf16 v[248:251], v[60:63], v[120:123], v[248:251]
    ds_read_b64_tr_b16 v[46:47], v15 offset:33280
    v_mfma_f32_16x16x32_bf16 v[252:255], v[60:63], v[124:127], v[252:255]
    s_waitcnt vmcnt(18)
    s_waitcnt lgkmcnt(12)
    v_mfma_f32_16x16x32_bf16 v[128:131], v[32:35], v[64:67], v[128:131]
    ds_read_b64_tr_b16 v[60:61], v15 offset:40960
    v_mfma_f32_16x16x32_bf16 v[132:135], v[32:35], v[68:71], v[132:135]
    buffer_load_dwordx4 v[112:115], v11, s[24:27], s54 offen offset:2048
    v_mfma_f32_16x16x32_bf16 v[136:139], v[32:35], v[72:75], v[136:139]
    ds_read_b64_tr_b16 v[62:63], v15 offset:41472
    v_mfma_f32_16x16x32_bf16 v[140:143], v[32:35], v[76:79], v[140:143]
    s_waitcnt lgkmcnt(12)
    v_mfma_f32_16x16x32_bf16 v[192:195], v[48:51], v[64:67], v[192:195]
    ds_read_b64_tr_b16 v[32:33], v12 offset:36864
    v_mfma_f32_16x16x32_bf16 v[196:199], v[48:51], v[68:71], v[196:199]
    buffer_load_dwordx4 v[116:119], v11, s[24:27], s54 offen offset:2304
    v_mfma_f32_16x16x32_bf16 v[200:203], v[48:51], v[72:75], v[200:203]
    ds_read_b64_tr_b16 v[34:35], v12 offset:37376
    v_mfma_f32_16x16x32_bf16 v[204:207], v[48:51], v[76:79], v[204:207]
    s_waitcnt lgkmcnt(12)
    v_mfma_f32_16x16x32_bf16 v[144:147], v[36:39], v[64:67], v[144:147]
    ds_read_b64_tr_b16 v[48:49], v12 offset:45056
    v_mfma_f32_16x16x32_bf16 v[148:151], v[36:39], v[68:71], v[148:151]
    buffer_load_dwordx4 v[120:123], v11, s[24:27], s55 offen offset:2048
    v_mfma_f32_16x16x32_bf16 v[152:155], v[36:39], v[72:75], v[152:155]
    ds_read_b64_tr_b16 v[50:51], v12 offset:45568
    v_mfma_f32_16x16x32_bf16 v[156:159], v[36:39], v[76:79], v[156:159]
    s_waitcnt lgkmcnt(12)
    v_mfma_f32_16x16x32_bf16 v[208:211], v[52:55], v[64:67], v[208:211]
    ds_read_b64_tr_b16 v[36:37], v13 offset:36864
    v_mfma_f32_16x16x32_bf16 v[212:215], v[52:55], v[68:71], v[212:215]
    buffer_load_dwordx4 v[124:127], v11, s[24:27], s55 offen offset:2304
    v_mfma_f32_16x16x32_bf16 v[216:219], v[52:55], v[72:75], v[216:219]
    ds_read_b64_tr_b16 v[38:39], v13 offset:37376
    v_mfma_f32_16x16x32_bf16 v[220:223], v[52:55], v[76:79], v[220:223]
    s_waitcnt lgkmcnt(12)
    v_mfma_f32_16x16x32_bf16 v[160:163], v[40:43], v[64:67], v[160:163]
    ds_read_b64_tr_b16 v[52:53], v13 offset:45056
    v_mfma_f32_16x16x32_bf16 v[164:167], v[40:43], v[68:71], v[164:167]
    v_mfma_f32_16x16x32_bf16 v[168:171], v[40:43], v[72:75], v[168:171]
    ds_read_b64_tr_b16 v[54:55], v13 offset:45568
    v_mfma_f32_16x16x32_bf16 v[172:175], v[40:43], v[76:79], v[172:175]
    s_waitcnt lgkmcnt(12)
    v_mfma_f32_16x16x32_bf16 v[224:227], v[56:59], v[64:67], v[224:227]
    ds_read_b64_tr_b16 v[40:41], v14 offset:36864
    v_mfma_f32_16x16x32_bf16 v[228:231], v[56:59], v[68:71], v[228:231]
    s_add_u32 s57, s56, 57344
    buffer_load_dword v19, v18, s[20:23], s57 offen
    v_mfma_f32_16x16x32_bf16 v[232:235], v[56:59], v[72:75], v[232:235]
    ds_read_b64_tr_b16 v[42:43], v14 offset:37376
    v_mfma_f32_16x16x32_bf16 v[236:239], v[56:59], v[76:79], v[236:239]
    s_waitcnt lgkmcnt(12)
    v_mfma_f32_16x16x32_bf16 v[176:179], v[44:47], v[64:67], v[176:179]
    ds_read_b64_tr_b16 v[56:57], v14 offset:45056
    v_mfma_f32_16x16x32_bf16 v[180:183], v[44:47], v[68:71], v[180:183]
    v_mfma_f32_16x16x32_bf16 v[184:187], v[44:47], v[72:75], v[184:187]
    ds_read_b64_tr_b16 v[58:59], v14 offset:45568
    v_mfma_f32_16x16x32_bf16 v[188:191], v[44:47], v[76:79], v[188:191]
    s_waitcnt lgkmcnt(12)
    v_mfma_f32_16x16x32_bf16 v[240:243], v[60:63], v[64:67], v[240:243]
    ds_read_b64_tr_b16 v[44:45], v15 offset:36864
    v_mfma_f32_16x16x32_bf16 v[244:247], v[60:63], v[68:71], v[244:247]
    s_add_u32 s57, s56, 61440
    buffer_load_dword v19, v18, s[20:23], s57 offen
    v_mfma_f32_16x16x32_bf16 v[248:251], v[60:63], v[72:75], v[248:251]
    ds_read_b64_tr_b16 v[46:47], v15 offset:37376
    v_mfma_f32_16x16x32_bf16 v[252:255], v[60:63], v[76:79], v[252:255]
    s_waitcnt vmcnt(13)
    s_barrier
    s_waitcnt lgkmcnt(12)
    v_mfma_f32_16x16x32_bf16 v[128:131], v[32:35], v[80:83], v[128:131]
    ds_read_b64_tr_b16 v[60:61], v15 offset:45056
    v_mfma_f32_16x16x32_bf16 v[132:135], v[32:35], v[84:87], v[132:135]
    v_mfma_f32_16x16x32_bf16 v[136:139], v[32:35], v[88:91], v[136:139]
    ds_read_b64_tr_b16 v[62:63], v15 offset:45568
    v_mfma_f32_16x16x32_bf16 v[140:143], v[32:35], v[92:95], v[140:143]
    s_waitcnt lgkmcnt(12)
    v_mfma_f32_16x16x32_bf16 v[192:195], v[48:51], v[80:83], v[192:195]
    ds_read_b64_tr_b16 v[32:33], v12 offset:49152
    v_mfma_f32_16x16x32_bf16 v[196:199], v[48:51], v[84:87], v[196:199]
    v_mfma_f32_16x16x32_bf16 v[200:203], v[48:51], v[88:91], v[200:203]
    ds_read_b64_tr_b16 v[34:35], v12 offset:49664
    v_mfma_f32_16x16x32_bf16 v[204:207], v[48:51], v[92:95], v[204:207]
    s_waitcnt lgkmcnt(12)
    v_mfma_f32_16x16x32_bf16 v[144:147], v[36:39], v[80:83], v[144:147]
    ds_read_b64_tr_b16 v[48:49], v12 offset:57344
    v_mfma_f32_16x16x32_bf16 v[148:151], v[36:39], v[84:87], v[148:151]
    v_mfma_f32_16x16x32_bf16 v[152:155], v[36:39], v[88:91], v[152:155]
    ds_read_b64_tr_b16 v[50:51], v12 offset:57856
    v_mfma_f32_16x16x32_bf16 v[156:159], v[36:39], v[92:95], v[156:159]
    s_waitcnt lgkmcnt(12)
    v_mfma_f32_16x16x32_bf16 v[208:211], v[52:55], v[80:83], v[208:211]
    ds_read_b64_tr_b16 v[36:37], v13 offset:49152
    v_mfma_f32_16x16x32_bf16 v[212:215], v[52:55], v[84:87], v[212:215]
    v_mfma_f32_16x16x32_bf16 v[216:219], v[52:55], v[88:91], v[216:219]
    ds_read_b64_tr_b16 v[38:39], v13 offset:49664
    v_mfma_f32_16x16x32_bf16 v[220:223], v[52:55], v[92:95], v[220:223]
    s_waitcnt lgkmcnt(12)
    v_mfma_f32_16x16x32_bf16 v[160:163], v[40:43], v[80:83], v[160:163]
    ds_read_b64_tr_b16 v[52:53], v13 offset:57344
    v_mfma_f32_16x16x32_bf16 v[164:167], v[40:43], v[84:87], v[164:167]
    v_mfma_f32_16x16x32_bf16 v[168:171], v[40:43], v[88:91], v[168:171]
    ds_read_b64_tr_b16 v[54:55], v13 offset:57856
    v_mfma_f32_16x16x32_bf16 v[172:175], v[40:43], v[92:95], v[172:175]
    s_waitcnt lgkmcnt(12)
    v_mfma_f32_16x16x32_bf16 v[224:227], v[56:59], v[80:83], v[224:227]
    ds_read_b64_tr_b16 v[40:41], v14 offset:49152
    v_mfma_f32_16x16x32_bf16 v[228:231], v[56:59], v[84:87], v[228:231]
    s_add_u32 s57, s58, 0
    buffer_load_dword v19, v18, s[24:27], s57 offen
    v_mfma_f32_16x16x32_bf16 v[232:235], v[56:59], v[88:91], v[232:235]
    ds_read_b64_tr_b16 v[42:43], v14 offset:49664
    v_mfma_f32_16x16x32_bf16 v[236:239], v[56:59], v[92:95], v[236:239]
    s_waitcnt lgkmcnt(12)
    v_mfma_f32_16x16x32_bf16 v[176:179], v[44:47], v[80:83], v[176:179]
    ds_read_b64_tr_b16 v[56:57], v14 offset:57344
    v_mfma_f32_16x16x32_bf16 v[180:183], v[44:47], v[84:87], v[180:183]
    v_mfma_f32_16x16x32_bf16 v[184:187], v[44:47], v[88:91], v[184:187]
    ds_read_b64_tr_b16 v[58:59], v14 offset:57856
    v_mfma_f32_16x16x32_bf16 v[188:191], v[44:47], v[92:95], v[188:191]
    s_waitcnt lgkmcnt(12)
    v_mfma_f32_16x16x32_bf16 v[240:243], v[60:63], v[80:83], v[240:243]
    ds_read_b64_tr_b16 v[44:45], v15 offset:49152
    v_mfma_f32_16x16x32_bf16 v[244:247], v[60:63], v[84:87], v[244:247]
    s_add_u32 s57, s58, 4096
    buffer_load_dword v19, v18, s[24:27], s57 offen
    v_mfma_f32_16x16x32_bf16 v[248:251], v[60:63], v[88:91], v[248:251]
    ds_read_b64_tr_b16 v[46:47], v15 offset:49664
    v_mfma_f32_16x16x32_bf16 v[252:255], v[60:63], v[92:95], v[252:255]
    s_waitcnt vmcnt(10)
    s_waitcnt lgkmcnt(12)
    v_mfma_f32_16x16x32_bf16 v[128:131], v[32:35], v[96:99], v[128:131]
    ds_read_b64_tr_b16 v[60:61], v15 offset:57344
    v_mfma_f32_16x16x32_bf16 v[132:135], v[32:35], v[100:103], v[132:135]
    v_mfma_f32_16x16x32_bf16 v[136:139], v[32:35], v[104:107], v[136:139]
    ds_read_b64_tr_b16 v[62:63], v15 offset:57856
    v_mfma_f32_16x16x32_bf16 v[140:143], v[32:35], v[108:111], v[140:143]
    s_waitcnt lgkmcnt(12)
    v_mfma_f32_16x16x32_bf16 v[192:195], v[48:51], v[96:99], v[192:195]
    ds_read_b64_tr_b16 v[32:33], v12 offset:53248
    v_mfma_f32_16x16x32_bf16 v[196:199], v[48:51], v[100:103], v[196:199]
    v_mfma_f32_16x16x32_bf16 v[200:203], v[48:51], v[104:107], v[200:203]
    ds_read_b64_tr_b16 v[34:35], v12 offset:53760
    v_mfma_f32_16x16x32_bf16 v[204:207], v[48:51], v[108:111], v[204:207]
    s_waitcnt lgkmcnt(12)
    v_mfma_f32_16x16x32_bf16 v[144:147], v[36:39], v[96:99], v[144:147]
    ds_read_b64_tr_b16 v[48:49], v12 offset:61440
    v_mfma_f32_16x16x32_bf16 v[148:151], v[36:39], v[100:103], v[148:151]
    v_mfma_f32_16x16x32_bf16 v[152:155], v[36:39], v[104:107], v[152:155]
    ds_read_b64_tr_b16 v[50:51], v12 offset:61952
    v_mfma_f32_16x16x32_bf16 v[156:159], v[36:39], v[108:111], v[156:159]
    s_waitcnt lgkmcnt(12)
    v_mfma_f32_16x16x32_bf16 v[208:211], v[52:55], v[96:99], v[208:211]
    ds_read_b64_tr_b16 v[36:37], v13 offset:53248
    v_mfma_f32_16x16x32_bf16 v[212:215], v[52:55], v[100:103], v[212:215]
    v_mfma_f32_16x16x32_bf16 v[216:219], v[52:55], v[104:107], v[216:219]
    ds_read_b64_tr_b16 v[38:39], v13 offset:53760
    v_mfma_f32_16x16x32_bf16 v[220:223], v[52:55], v[108:111], v[220:223]
    s_waitcnt lgkmcnt(12)
    v_mfma_f32_16x16x32_bf16 v[160:163], v[40:43], v[96:99], v[160:163]
    ds_read_b64_tr_b16 v[52:53], v13 offset:61440
    v_mfma_f32_16x16x32_bf16 v[164:167], v[40:43], v[100:103], v[164:167]
    v_mfma_f32_16x16x32_bf16 v[168:171], v[40:43], v[104:107], v[168:171]
    ds_read_b64_tr_b16 v[54:55], v13 offset:61952
    v_mfma_f32_16x16x32_bf16 v[172:175], v[40:43], v[108:111], v[172:175]
    s_waitcnt lgkmcnt(12)
    v_mfma_f32_16x16x32_bf16 v[224:227], v[56:59], v[96:99], v[224:227]
    ds_read_b64_tr_b16 v[40:41], v14 offset:53248
    v_mfma_f32_16x16x32_bf16 v[228:231], v[56:59], v[100:103], v[228:231]
    s_add_u32 s57, s58, 8192
    buffer_load_dword v19, v18, s[24:27], s57 offen
    v_mfma_f32_16x16x32_bf16 v[232:235], v[56:59], v[104:107], v[232:235]
    ds_read_b64_tr_b16 v[42:43], v14 offset:53760
    v_mfma_f32_16x16x32_bf16 v[236:239], v[56:59], v[108:111], v[236:239]
    s_waitcnt lgkmcnt(12)
    v_mfma_f32_16x16x32_bf16 v[176:179], v[44:47], v[96:99], v[176:179]
    ds_read_b64_tr_b16 v[56:57], v14 offset:61440
    v_mfma_f32_16x16x32_bf16 v[180:183], v[44:47], v[100:103], v[180:183]
    v_mfma_f32_16x16x32_bf16 v[184:187], v[44:47], v[104:107], v[184:187]
    ds_read_b64_tr_b16 v[58:59], v14 offset:61952
    v_mfma_f32_16x16x32_bf16 v[188:191], v[44:47], v[108:111], v[188:191]
    s_waitcnt lgkmcnt(12)
    v_mfma_f32_16x16x32_bf16 v[240:243], v[60:63], v[96:99], v[240:243]
    ds_read_b64_tr_b16 v[44:45], v15 offset:53248
    v_mfma_f32_16x16x32_bf16 v[244:247], v[60:63], v[100:103], v[244:247]
    s_add_u32 s57, s58, 12288
    buffer_load_dword v19, v18, s[24:27], s57 offen
    v_mfma_f32_16x16x32_bf16 v[248:251], v[60:63], v[104:107], v[248:251]
    ds_read_b64_tr_b16 v[46:47], v15 offset:53760
    v_mfma_f32_16x16x32_bf16 v[252:255], v[60:63], v[108:111], v[252:255]
    s_waitcnt vmcnt(6)
    s_waitcnt lgkmcnt(12)
    v_mfma_f32_16x16x32_bf16 v[128:131], v[32:35], v[112:115], v[128:131]
    ds_read_b64_tr_b16 v[60:61], v15 offset:61440
    v_mfma_f32_16x16x32_bf16 v[132:135], v[32:35], v[116:119], v[132:135]
    v_mfma_f32_16x16x32_bf16 v[136:139], v[32:35], v[120:123], v[136:139]
    ds_read_b64_tr_b16 v[62:63], v15 offset:61952
    v_mfma_f32_16x16x32_bf16 v[140:143], v[32:35], v[124:127], v[140:143]
    s_waitcnt lgkmcnt(12)
    v_mfma_f32_16x16x32_bf16 v[192:195], v[48:51], v[112:115], v[192:195]
    v_mfma_f32_16x16x32_bf16 v[196:199], v[48:51], v[116:119], v[196:199]
    v_mfma_f32_16x16x32_bf16 v[200:203], v[48:51], v[120:123], v[200:203]
    v_mfma_f32_16x16x32_bf16 v[204:207], v[48:51], v[124:127], v[204:207]
    s_waitcnt lgkmcnt(10)
    v_mfma_f32_16x16x32_bf16 v[144:147], v[36:39], v[112:115], v[144:147]
    v_mfma_f32_16x16x32_bf16 v[148:151], v[36:39], v[116:119], v[148:151]
    v_mfma_f32_16x16x32_bf16 v[152:155], v[36:39], v[120:123], v[152:155]
    v_mfma_f32_16x16x32_bf16 v[156:159], v[36:39], v[124:127], v[156:159]
    s_waitcnt lgkmcnt(8)
    v_mfma_f32_16x16x32_bf16 v[208:211], v[52:55], v[112:115], v[208:211]
    v_mfma_f32_16x16x32_bf16 v[212:215], v[52:55], v[116:119], v[212:215]
    v_mfma_f32_16x16x32_bf16 v[216:219], v[52:55], v[120:123], v[216:219]
    v_mfma_f32_16x16x32_bf16 v[220:223], v[52:55], v[124:127], v[220:223]
    s_waitcnt lgkmcnt(6)
    v_mfma_f32_16x16x32_bf16 v[160:163], v[40:43], v[112:115], v[160:163]
    v_mfma_f32_16x16x32_bf16 v[164:167], v[40:43], v[116:119], v[164:167]
    v_mfma_f32_16x16x32_bf16 v[168:171], v[40:43], v[120:123], v[168:171]
    v_mfma_f32_16x16x32_bf16 v[172:175], v[40:43], v[124:127], v[172:175]
    s_waitcnt lgkmcnt(4)
    v_mfma_f32_16x16x32_bf16 v[224:227], v[56:59], v[112:115], v[224:227]
    v_mfma_f32_16x16x32_bf16 v[228:231], v[56:59], v[116:119], v[228:231]
    s_add_u32 s57, s58, 16384
    buffer_load_dword v19, v18, s[24:27], s57 offen
    v_mfma_f32_16x16x32_bf16 v[232:235], v[56:59], v[120:123], v[232:235]
    v_mfma_f32_16x16x32_bf16 v[236:239], v[56:59], v[124:127], v[236:239]
    s_waitcnt lgkmcnt(2)
    v_mfma_f32_16x16x32_bf16 v[176:179], v[44:47], v[112:115], v[176:179]
    v_mfma_f32_16x16x32_bf16 v[180:183], v[44:47], v[116:119], v[180:183]
    v_mfma_f32_16x16x32_bf16 v[184:187], v[44:47], v[120:123], v[184:187]
    v_mfma_f32_16x16x32_bf16 v[188:191], v[44:47], v[124:127], v[188:191]
    s_waitcnt lgkmcnt(0)
    v_mfma_f32_16x16x32_bf16 v[240:243], v[60:63], v[112:115], v[240:243]
    v_mfma_f32_16x16x32_bf16 v[244:247], v[60:63], v[116:119], v[244:247]
    v_mfma_f32_16x16x32_bf16 v[248:251], v[60:63], v[120:123], v[248:251]
    v_mfma_f32_16x16x32_bf16 v[252:255], v[60:63], v[124:127], v[252:255]
    v_cvt_pk_bf16_f32 v32, v128, v129
    v_cvt_pk_bf16_f32 v36, v192, v193
    v_cvt_pk_bf16_f32 v33, v130, v131
    v_cvt_pk_bf16_f32 v37, v194, v195
    v_cvt_pk_bf16_f32 v34, v144, v145
    v_cvt_pk_bf16_f32 v38, v208, v209
    v_cvt_pk_bf16_f32 v35, v146, v147
    v_cvt_pk_bf16_f32 v39, v210, v211
    v_pk_max_i16 v32, v32, 0
    v_pk_max_i16 v33, v33, 0
    v_pk_max_i16 v34, v34, 0
    v_pk_max_i16 v35, v35, 0
    v_lshlrev_b32 v128, 16, v32
    v_and_b32 v129, 0xffff0000, v32
    v_lshlrev_b32 v192, 16, v36
    v_and_b32 v193, 0xffff0000, v36
    v_lshlrev_b32 v130, 16, v33
    v_and_b32 v131, 0xffff0000, v33
    v_lshlrev_b32 v194, 16, v37
    v_and_b32 v195, 0xffff0000, v37
    v_lshlrev_b32 v144, 16, v34
    v_and_b32 v145, 0xffff0000, v34
    v_lshlrev_b32 v208, 16, v38
    v_and_b32 v209, 0xffff0000, v38
    v_lshlrev_b32 v146, 16, v35
    v_and_b32 v147, 0xffff0000, v35
    v_lshlrev_b32 v210, 16, v39
    v_and_b32 v211, 0xffff0000, v39
    v_pk_mul_f32 v[128:129], v[128:129], v[192:193]
    v_pk_mul_f32 v[130:131], v[130:131], v[194:195]
    v_pk_mul_f32 v[144:145], v[144:145], v[208:209]
    v_pk_mul_f32 v[146:147], v[146:147], v[210:211]
    v_cvt_pk_bf16_f32 v32, v128, v129
    v_cvt_pk_bf16_f32 v33, v130, v131
    v_cvt_pk_bf16_f32 v34, v144, v145
    v_cvt_pk_bf16_f32 v35, v146, v147
    buffer_store_dwordx4 v[32:35], v16, s[24:27], s60 offen offset:0 sc1
    v_cvt_pk_bf16_f32 v40, v132, v133
    v_cvt_pk_bf16_f32 v44, v196, v197
    v_cvt_pk_bf16_f32 v41, v134, v135
    v_cvt_pk_bf16_f32 v45, v198, v199
    v_cvt_pk_bf16_f32 v42, v148, v149
    v_cvt_pk_bf16_f32 v46, v212, v213
    v_cvt_pk_bf16_f32 v43, v150, v151
    v_cvt_pk_bf16_f32 v47, v214, v215
    v_pk_max_i16 v40, v40, 0
    v_pk_max_i16 v41, v41, 0
    v_pk_max_i16 v42, v42, 0
    v_pk_max_i16 v43, v43, 0
    v_lshlrev_b32 v132, 16, v40
    v_and_b32 v133, 0xffff0000, v40
    v_lshlrev_b32 v196, 16, v44
    v_and_b32 v197, 0xffff0000, v44
    v_lshlrev_b32 v134, 16, v41
    v_and_b32 v135, 0xffff0000, v41
    v_lshlrev_b32 v198, 16, v45
    v_and_b32 v199, 0xffff0000, v45
    v_lshlrev_b32 v148, 16, v42
    v_and_b32 v149, 0xffff0000, v42
    v_lshlrev_b32 v212, 16, v46
    v_and_b32 v213, 0xffff0000, v46
    v_lshlrev_b32 v150, 16, v43
    v_and_b32 v151, 0xffff0000, v43
    v_lshlrev_b32 v214, 16, v47
    v_and_b32 v215, 0xffff0000, v47
    v_pk_mul_f32 v[132:133], v[132:133], v[196:197]
    v_pk_mul_f32 v[134:135], v[134:135], v[198:199]
    v_pk_mul_f32 v[148:149], v[148:149], v[212:213]
    v_pk_mul_f32 v[150:151], v[150:151], v[214:215]
    v_cvt_pk_bf16_f32 v40, v132, v133
    v_cvt_pk_bf16_f32 v41, v134, v135
    v_cvt_pk_bf16_f32 v42, v148, v149
    v_cvt_pk_bf16_f32 v43, v150, v151
    buffer_store_dwordx4 v[40:43], v16, s[24:27], s61 offen offset:0 sc1
    v_cvt_pk_bf16_f32 v48, v136, v137
    v_cvt_pk_bf16_f32 v52, v200, v201
    v_cvt_pk_bf16_f32 v49, v138, v139
    v_cvt_pk_bf16_f32 v53, v202, v203
    v_cvt_pk_bf16_f32 v50, v152, v153
    v_cvt_pk_bf16_f32 v54, v216, v217
    v_cvt_pk_bf16_f32 v51, v154, v155
    v_cvt_pk_bf16_f32 v55, v218, v219
    v_pk_max_i16 v48, v48, 0
    v_pk_max_i16 v49, v49, 0
    v_pk_max_i16 v50, v50, 0
    v_pk_max_i16 v51, v51, 0
    v_lshlrev_b32 v136, 16, v48
    v_and_b32 v137, 0xffff0000, v48
    v_lshlrev_b32 v200, 16, v52
    v_and_b32 v201, 0xffff0000, v52
    v_lshlrev_b32 v138, 16, v49
    v_and_b32 v139, 0xffff0000, v49
    v_lshlrev_b32 v202, 16, v53
    v_and_b32 v203, 0xffff0000, v53
    v_lshlrev_b32 v152, 16, v50
    v_and_b32 v153, 0xffff0000, v50
    v_lshlrev_b32 v216, 16, v54
    v_and_b32 v217, 0xffff0000, v54
    v_lshlrev_b32 v154, 16, v51
    v_and_b32 v155, 0xffff0000, v51
    v_lshlrev_b32 v218, 16, v55
    v_and_b32 v219, 0xffff0000, v55
    v_pk_mul_f32 v[136:137], v[136:137], v[200:201]
    v_pk_mul_f32 v[138:139], v[138:139], v[202:203]
    v_pk_mul_f32 v[152:153], v[152:153], v[216:217]
    v_pk_mul_f32 v[154:155], v[154:155], v[218:219]
    v_cvt_pk_bf16_f32 v48, v136, v137
    v_cvt_pk_bf16_f32 v49, v138, v139
    v_cvt_pk_bf16_f32 v50, v152, v153
    v_cvt_pk_bf16_f32 v51, v154, v155
    buffer_store_dwordx4 v[48:51], v16, s[24:27], s62 offen offset:0 sc1
    v_cvt_pk_bf16_f32 v56, v140, v141
    v_cvt_pk_bf16_f32 v60, v204, v205
    v_cvt_pk_bf16_f32 v57, v142, v143
    v_cvt_pk_bf16_f32 v61, v206, v207
    v_cvt_pk_bf16_f32 v58, v156, v157
    v_cvt_pk_bf16_f32 v62, v220, v221
    v_cvt_pk_bf16_f32 v59, v158, v159
    v_cvt_pk_bf16_f32 v63, v222, v223
    v_pk_max_i16 v56, v56, 0
    v_pk_max_i16 v57, v57, 0
    v_pk_max_i16 v58, v58, 0
    v_pk_max_i16 v59, v59, 0
    v_lshlrev_b32 v140, 16, v56
    v_and_b32 v141, 0xffff0000, v56
    v_lshlrev_b32 v204, 16, v60
    v_and_b32 v205, 0xffff0000, v60
    v_lshlrev_b32 v142, 16, v57
    v_and_b32 v143, 0xffff0000, v57
    v_lshlrev_b32 v206, 16, v61
    v_and_b32 v207, 0xffff0000, v61
    v_lshlrev_b32 v156, 16, v58
    v_and_b32 v157, 0xffff0000, v58
    v_lshlrev_b32 v220, 16, v62
    v_and_b32 v221, 0xffff0000, v62
    v_lshlrev_b32 v158, 16, v59
    v_and_b32 v159, 0xffff0000, v59
    v_lshlrev_b32 v222, 16, v63
    v_and_b32 v223, 0xffff0000, v63
    v_pk_mul_f32 v[140:141], v[140:141], v[204:205]
    v_pk_mul_f32 v[142:143], v[142:143], v[206:207]
    v_pk_mul_f32 v[156:157], v[156:157], v[220:221]
    v_pk_mul_f32 v[158:159], v[158:159], v[222:223]
    v_cvt_pk_bf16_f32 v56, v140, v141
    v_cvt_pk_bf16_f32 v57, v142, v143
    v_cvt_pk_bf16_f32 v58, v156, v157
    v_cvt_pk_bf16_f32 v59, v158, v159
    buffer_store_dwordx4 v[56:59], v16, s[24:27], s63 offen offset:0 sc1
    v_cvt_pk_bf16_f32 v32, v160, v161
    v_cvt_pk_bf16_f32 v36, v224, v225
    v_cvt_pk_bf16_f32 v33, v162, v163
    v_cvt_pk_bf16_f32 v37, v226, v227
    v_cvt_pk_bf16_f32 v34, v176, v177
    v_cvt_pk_bf16_f32 v38, v240, v241
    v_cvt_pk_bf16_f32 v35, v178, v179
    v_cvt_pk_bf16_f32 v39, v242, v243
    v_pk_max_i16 v32, v32, 0
    v_pk_max_i16 v33, v33, 0
    v_pk_max_i16 v34, v34, 0
    v_pk_max_i16 v35, v35, 0
    v_lshlrev_b32 v160, 16, v32
    v_and_b32 v161, 0xffff0000, v32
    v_lshlrev_b32 v224, 16, v36
    v_and_b32 v225, 0xffff0000, v36
    v_lshlrev_b32 v162, 16, v33
    v_and_b32 v163, 0xffff0000, v33
    v_lshlrev_b32 v226, 16, v37
    v_and_b32 v227, 0xffff0000, v37
    v_lshlrev_b32 v176, 16, v34
    v_and_b32 v177, 0xffff0000, v34
    v_lshlrev_b32 v240, 16, v38
    v_and_b32 v241, 0xffff0000, v38
    v_lshlrev_b32 v178, 16, v35
    v_and_b32 v179, 0xffff0000, v35
    v_lshlrev_b32 v242, 16, v39
    v_and_b32 v243, 0xffff0000, v39
    v_pk_mul_f32 v[160:161], v[160:161], v[224:225]
    v_pk_mul_f32 v[162:163], v[162:163], v[226:227]
    v_pk_mul_f32 v[176:177], v[176:177], v[240:241]
    v_pk_mul_f32 v[178:179], v[178:179], v[242:243]
    v_cvt_pk_bf16_f32 v32, v160, v161
    v_cvt_pk_bf16_f32 v33, v162, v163
    v_cvt_pk_bf16_f32 v34, v176, v177
    v_cvt_pk_bf16_f32 v35, v178, v179
    buffer_store_dwordx4 v[32:35], v16, s[24:27], s60 offen offset:1024 sc1
    v_cvt_pk_bf16_f32 v40, v164, v165
    v_cvt_pk_bf16_f32 v44, v228, v229
    v_cvt_pk_bf16_f32 v41, v166, v167
    v_cvt_pk_bf16_f32 v45, v230, v231
    v_cvt_pk_bf16_f32 v42, v180, v181
    v_cvt_pk_bf16_f32 v46, v244, v245
    v_cvt_pk_bf16_f32 v43, v182, v183
    v_cvt_pk_bf16_f32 v47, v246, v247
    v_pk_max_i16 v40, v40, 0
    v_pk_max_i16 v41, v41, 0
    v_pk_max_i16 v42, v42, 0
    v_pk_max_i16 v43, v43, 0
    v_lshlrev_b32 v164, 16, v40
    v_and_b32 v165, 0xffff0000, v40
    v_lshlrev_b32 v228, 16, v44
    v_and_b32 v229, 0xffff0000, v44
    v_lshlrev_b32 v166, 16, v41
    v_and_b32 v167, 0xffff0000, v41
    v_lshlrev_b32 v230, 16, v45
    v_and_b32 v231, 0xffff0000, v45
    v_lshlrev_b32 v180, 16, v42
    v_and_b32 v181, 0xffff0000, v42
    v_lshlrev_b32 v244, 16, v46
    v_and_b32 v245, 0xffff0000, v46
    v_lshlrev_b32 v182, 16, v43
    v_and_b32 v183, 0xffff0000, v43
    v_lshlrev_b32 v246, 16, v47
    v_and_b32 v247, 0xffff0000, v47
    v_pk_mul_f32 v[164:165], v[164:165], v[228:229]
    v_pk_mul_f32 v[166:167], v[166:167], v[230:231]
    v_pk_mul_f32 v[180:181], v[180:181], v[244:245]
    v_pk_mul_f32 v[182:183], v[182:183], v[246:247]
    v_cvt_pk_bf16_f32 v40, v164, v165
    v_cvt_pk_bf16_f32 v41, v166, v167
    v_cvt_pk_bf16_f32 v42, v180, v181
    v_cvt_pk_bf16_f32 v43, v182, v183
    buffer_store_dwordx4 v[40:43], v16, s[24:27], s61 offen offset:1024 sc1
    v_cvt_pk_bf16_f32 v48, v168, v169
    v_cvt_pk_bf16_f32 v52, v232, v233
    v_cvt_pk_bf16_f32 v49, v170, v171
    v_cvt_pk_bf16_f32 v53, v234, v235
    v_cvt_pk_bf16_f32 v50, v184, v185
    v_cvt_pk_bf16_f32 v54, v248, v249
    v_cvt_pk_bf16_f32 v51, v186, v187
    v_cvt_pk_bf16_f32 v55, v250, v251
    v_pk_max_i16 v48, v48, 0
    v_pk_max_i16 v49, v49, 0
    v_pk_max_i16 v50, v50, 0
    v_pk_max_i16 v51, v51, 0
    v_lshlrev_b32 v168, 16, v48
    v_and_b32 v169, 0xffff0000, v48
    v_lshlrev_b32 v232, 16, v52
    v_and_b32 v233, 0xffff0000, v52
    v_lshlrev_b32 v170, 16, v49
    v_and_b32 v171, 0xffff0000, v49
    v_lshlrev_b32 v234, 16, v53
    v_and_b32 v235, 0xffff0000, v53
    v_lshlrev_b32 v184, 16, v50
    v_and_b32 v185, 0xffff0000, v50
    v_lshlrev_b32 v248, 16, v54
    v_and_b32 v249, 0xffff0000, v54
    v_lshlrev_b32 v186, 16, v51
    v_and_b32 v187, 0xffff0000, v51
    v_lshlrev_b32 v250, 16, v55
    v_and_b32 v251, 0xffff0000, v55
    v_pk_mul_f32 v[168:169], v[168:169], v[232:233]
    v_pk_mul_f32 v[170:171], v[170:171], v[234:235]
    v_pk_mul_f32 v[184:185], v[184:185], v[248:249]
    v_pk_mul_f32 v[186:187], v[186:187], v[250:251]
    v_cvt_pk_bf16_f32 v48, v168, v169
    v_cvt_pk_bf16_f32 v49, v170, v171
    v_cvt_pk_bf16_f32 v50, v184, v185
    v_cvt_pk_bf16_f32 v51, v186, v187
    buffer_store_dwordx4 v[48:51], v16, s[24:27], s62 offen offset:1024 sc1
    v_cvt_pk_bf16_f32 v56, v172, v173
    v_cvt_pk_bf16_f32 v60, v236, v237
    v_cvt_pk_bf16_f32 v57, v174, v175
    v_cvt_pk_bf16_f32 v61, v238, v239
    v_cvt_pk_bf16_f32 v58, v188, v189
    v_cvt_pk_bf16_f32 v62, v252, v253
    v_cvt_pk_bf16_f32 v59, v190, v191
    v_cvt_pk_bf16_f32 v63, v254, v255
    v_pk_max_i16 v56, v56, 0
    v_pk_max_i16 v57, v57, 0
    v_pk_max_i16 v58, v58, 0
    v_pk_max_i16 v59, v59, 0
    v_lshlrev_b32 v172, 16, v56
    v_and_b32 v173, 0xffff0000, v56
    v_lshlrev_b32 v236, 16, v60
    v_and_b32 v237, 0xffff0000, v60
    v_lshlrev_b32 v174, 16, v57
    v_and_b32 v175, 0xffff0000, v57
    v_lshlrev_b32 v238, 16, v61
    v_and_b32 v239, 0xffff0000, v61
    v_lshlrev_b32 v188, 16, v58
    v_and_b32 v189, 0xffff0000, v58
    v_lshlrev_b32 v252, 16, v62
    v_and_b32 v253, 0xffff0000, v62
    v_lshlrev_b32 v190, 16, v59
    v_and_b32 v191, 0xffff0000, v59
    v_lshlrev_b32 v254, 16, v63
    v_and_b32 v255, 0xffff0000, v63
    v_pk_mul_f32 v[172:173], v[172:173], v[236:237]
    v_pk_mul_f32 v[174:175], v[174:175], v[238:239]
    v_pk_mul_f32 v[188:189], v[188:189], v[252:253]
    v_pk_mul_f32 v[190:191], v[190:191], v[254:255]
    v_cvt_pk_bf16_f32 v56, v172, v173
    v_cvt_pk_bf16_f32 v57, v174, v175
    v_cvt_pk_bf16_f32 v58, v188, v189
    v_cvt_pk_bf16_f32 v59, v190, v191
    buffer_store_dwordx4 v[56:59], v16, s[24:27], s63 offen offset:1024 sc1
    s_endpgm
L1_end:
    s_endpgm

.section .rodata,"a"
.p2align 6
.amdhsa_kernel l1_kernel
  .amdhsa_next_free_vgpr 256
  .amdhsa_next_free_sgpr 96
  .amdhsa_accum_offset 256
  .amdhsa_group_segment_fixed_size 0
  .amdhsa_kernarg_size 80
  .amdhsa_user_sgpr_count 2
  .amdhsa_user_sgpr_kernarg_segment_ptr 1
  .amdhsa_system_sgpr_workgroup_id_x 1
  .amdhsa_float_denorm_mode_32 3
.end_amdhsa_kernel
.text
.globl l2_kernel
.p2align 8
.type l2_kernel,@function
l2_kernel:
    s_cmp_ge_u32 s2, 256
    s_cbranch_scc1 L2_end
    s_load_dwordx2 s[4:5], s[0:1], 0
    s_load_dwordx2 s[6:7], s[0:1], 48
    s_load_dwordx2 s[8:9], s[0:1], 56
    s_load_dwordx2 s[10:11], s[0:1], 72
    s_and_b32 s40, s2, 7
    s_lshr_b32 s41, s2, 3
    s_lshl_b32 s42, s40, 2
    s_and_b32 s43, s41, 3
    s_add_u32 s42, s42, s43
    s_lshr_b32 s43, s41, 2
    v_lshrrev_b32 v1, 6, v0
    s_nop 0
    v_readfirstlane_b32 s44, v1
    v_and_b32 v1, 63, v0
    v_lshlrev_b32 v2, 4, v1
    v_and_b32 v3, 15, v1
    v_lshrrev_b32 v4, 4, v1
    s_cmp_lg_u32 s44, 0
    s_cbranch_scc1 L2_main
    v_lshlrev_b32 v16, 13, v4
    v_lshl_add_u32 v16, v3, 4, v16
    v_xor_b32 v17, 64, v16
    v_add_u32 v17, 32768, v17
    v_add_u32 v20, 65536, v16
    v_add_u32 v21, 65536, v17
    s_lshl_b32 s50, s42, 8
    s_add_u32 s50, s50, 17825792
    s_lshl_b32 s51, s43, 16
    s_add_u32 s51, s51, 19922944
    v_add_u32 v22, 16384, v2
    v_add_u32 v23, 32768, v2
    v_add_u32 v24, 49152, v2
    s_waitcnt lgkmcnt(0)
    s_mov_b32 s24, s10
    s_and_b32 s25, s11, 0xffff
    s_mov_b32 s26, 0x10000000
    s_mov_b32 s27, 0x00020000
    s_mov_b32 s16, s6
    s_and_b32 s17, s7, 0xffff
    s_mov_b32 s18, 0x1c0000
    s_mov_b32 s19, 0x00020000
    s_mov_b32 m0, 49152
    s_nop 0
    buffer_load_dwordx4 v16, s[24:27], s50 offen lds
    s_mov_b32 m0, 50176
    s_nop 0
    buffer_load_dwordx4 v17, s[24:27], s50 offen lds
    s_mov_b32 m0, 51200
    s_nop 0
    buffer_load_dwordx4 v20, s[24:27], s50 offen lds
    s_mov_b32 m0, 52224
    s_nop 0
    buffer_load_dwordx4 v21, s[24:27], s50 offen lds
    buffer_load_dwordx4 v[64:67], v2, s[24:27], s51 offen
    buffer_load_dwordx4 v[68:71], v22, s[24:27], s51 offen
    buffer_load_dwordx4 v[72:75], v23, s[24:27], s51 offen
    buffer_load_dwordx4 v[76:79], v24, s[24:27], s51 offen
    s_add_u32 s50, s50, 131072
    s_add_u32 s51, s51, 1024
    s_mov_b32 m0, 53248
    s_nop 0
    buffer_load_dwordx4 v16, s[24:27], s50 offen lds
    s_mov_b32 m0, 54272
    s_nop 0
    buffer_load_dwordx4 v17, s[24:27], s50 offen lds
    s_mov_b32 m0, 55296
    s_nop 0
    buffer_load_dwordx4 v20, s[24:27], s50 offen lds
    s_mov_b32 m0, 56320
    s_nop 0
    buffer_load_dwordx4 v21, s[24:27], s50 offen lds
    buffer_load_dwordx4 v[80:83], v2, s[24:27], s51 offen
    buffer_load_dwordx4 v[84:87], v22, s[24:27], s51 offen
    buffer_load_dwordx4 v[88:91], v23, s[24:27], s51 offen
    buffer_load_dwordx4 v[92:95], v24, s[24:27], s51 offen
    s_add_u32 s50, s50, 131072
    s_add_u32 s51, s51, 1024
    s_mov_b32 m0, 57344
    s_nop 0
    buffer_load_dwordx4 v16, s[24:27], s50 offen lds
    s_mov_b32 m0, 58368
    s_nop 0
    buffer_load_dwordx4 v17, s[24:27], s50 offen lds
    s_mov_b32 m0, 59392
    s_nop 0
    buffer_load_dwordx4 v20, s[24:27], s50 offen lds
    s_mov_b32 m0, 60416
    s_nop 0
    buffer_load_dwordx4 v21, s[24:27], s50 offen lds
    buffer_load_dwordx4 v[96:99], v2, s[24:27], s51 offen
    buffer_load_dwordx4 v[100:103], v22, s[24:27], s51 offen
    buffer_load_dwordx4 v[104:107], v23, s[24:27], s51 offen
    buffer_load_dwordx4 v[108:111], v24, s[24:27], s51 offen
    s_add_u32 s50, s50, 131072
    s_add_u32 s51, s51, 1024
    s_mov_b32 m0, 61440
    s_nop 0
    buffer_load_dwordx4 v16, s[24:27], s50 offen lds
    s_mov_b32 m0, 62464
    s_nop 0
    buffer_load_dwordx4 v17, s[24:27], s50 offen lds
    s_mov_b32 m0, 63488
    s_nop 0
    buffer_load_dwordx4 v20, s[24:27], s50 offen lds
    s_mov_b32 m0, 64512
    s_nop 0
    buffer_load_dwordx4 v21, s[24:27], s50 offen lds
    buffer_load_dwordx4 v[112:115], v2, s[24:27], s51 offen
    buffer_load_dwordx4 v[116:119], v22, s[24:27], s51 offen
    buffer_load_dwordx4 v[120:123], v23, s[24:27], s51 offen
    buffer_load_dwordx4 v[124:127], v24, s[24:27], s51 offen
    s_add_u32 s50, s50, 131072
    s_add_u32 s51, s51, 1024
    s_mov_b32 s12, s4
    s_and_b32 s13, s5, 0xffff
    s_mov_b32 s14, 0x200000
    s_mov_b32 s15, 0x00020000
    v_lshrrev_b32 v6, 2, v1
    v_and_b32 v7, 3, v1
    v_lshlrev_b32 v5, 10, v6
    v_lshl_add_u32 v5, v7, 5, v5
    s_lshl_b32 s45, s42, 16
    s_lshl_b32 s46, s44, 14
    s_add_u32 s45, s45, s46
    s_lshl_b32 s46, s43, 7
    s_add_u32 s45, s45, s46
    v_lshlrev_b32 v18, 10, v4
    v_lshl_add_u32 v18, v3, 2, v18
    v_and_b32 v19, 1, v4
    v_lshl_add_u32 v18, v19, 6, v18
    v_xor_b32 v19, 64, v18
    v_add_u32 v176, 49152, v18
    v_add_u32 v177, 49152, v19
    v_add_u32 v178, 53248, v18
    v_add_u32 v179, 53248, v19
    v_add_u32 v180, 57344, v18
    v_add_u32 v181, 57344, v19
    v_add_u32 v182, 61440, v18
    v_add_u32 v183, 61440, v19
    v_mov_b32 v192, 0
    v_mov_b32 v193, 0
    v_mov_b32 v194, 0
    v_mov_b32 v195, 0
    v_mov_b32 v196, 0
    v_mov_b32 v197, 0
    v_mov_b32 v198, 0
    v_mov_b32 v199, 0
    v_mov_b32 v200, 0
    v_mov_b32 v201, 0
    v_mov_b32 v202, 0
    v_mov_b32 v203, 0
    v_mov_b32 v204, 0
    v_mov_b32 v205, 0
    v_mov_b32 v206, 0
    v_mov_b32 v207, 0
    v_mov_b32 v208, 0
    v_mov_b32 v209, 0
    v_mov_b32 v210, 0
    v_mov_b32 v211, 0
    v_mov_b32 v212, 0
    v_mov_b32 v213, 0
    v_mov_b32 v214, 0
    v_mov_b32 v215, 0
    v_mov_b32 v216, 0
    v_mov_b32 v217, 0
    v_mov_b32 v218, 0
    v_mov_b32 v219, 0
    v_mov_b32 v220, 0
    v_mov_b32 v221, 0
    v_mov_b32 v222, 0
    v_mov_b32 v223, 0
    v_mov_b32 v224, 0
    v_mov_b32 v225, 0
    v_mov_b32 v226, 0
    v_mov_b32 v227, 0
    v_mov_b32 v228, 0
    v_mov_b32 v229, 0
    v_mov_b32 v230, 0
    v_mov_b32 v231, 0
    v_mov_b32 v232, 0
    v_mov_b32 v233, 0
    v_mov_b32 v234, 0
    v_mov_b32 v235, 0
    v_mov_b32 v236, 0
    v_mov_b32 v237, 0
    v_mov_b32 v238, 0
    v_mov_b32 v239, 0
    v_mov_b32 v240, 0
    v_mov_b32 v241, 0
    v_mov_b32 v242, 0
    v_mov_b32 v243, 0
    v_mov_b32 v244, 0
    v_mov_b32 v245, 0
    v_mov_b32 v246, 0
    v_mov_b32 v247, 0
    v_mov_b32 v248, 0
    v_mov_b32 v249, 0
    v_mov_b32 v250, 0
    v_mov_b32 v251, 0
    v_mov_b32 v252, 0
    v_mov_b32 v253, 0
    v_mov_b32 v254, 0
    v_mov_b32 v255, 0
    s_waitcnt vmcnt(24)
    ds_read2_b32 v[32:33], v176 offset0:0 offset1:64
    ds_read2_b32 v[34:35], v176 offset0:128 offset1:192
    ds_read2_b32 v[36:37], v177 offset0:0 offset1:64
    ds_read2_b32 v[38:39], v177 offset0:128 offset1:192
    ds_read2_b32 v[40:41], v176 offset0:32 offset1:96
    ds_read2_b32 v[42:43], v176 offset0:160 offset1:224
    ds_read2_b32 v[44:45], v177 offset0:32 offset1:96
    ds_read2_b32 v[46:47], v177 offset0:160 offset1:224
    s_mov_b32 s60, 0
L2_loop0:
    s_waitcnt lgkmcnt(6)
    s_waitcnt vmcnt(16)
    ds_read2_b32 v[48:49], v178 offset0:0 offset1:64
    ds_read2_b32 v[50:51], v178 offset0:128 offset1:192
    ds_read2_b32 v[52:53], v179 offset0:0 offset1:64
    ds_read2_b32 v[54:55], v179 offset0:128 offset1:192
    ds_read2_b32 v[56:57], v178 offset0:32 offset1:96
    ds_read2_b32 v[58:59], v178 offset0:160 offset1:224
    ds_read2_b32 v[60:61], v179 offset0:32 offset1:96
    ds_read2_b32 v[62:63], v179 offset0:160 offset1:224
    v_mfma_f32_16x16x32_bf16 v[192:195], v[64:67], v[32:35], v[192:195]
    v_mfma_f32_16x16x32_bf16 v[196:199], v[68:71], v[32:35], v[196:199]
    v_mfma_f32_16x16x32_bf16 v[200:203], v[72:75], v[32:35], v[200:203]
    v_mfma_f32_16x16x32_bf16 v[204:207], v[76:79], v[32:35], v[204:207]
    s_waitcnt lgkmcnt(12)
    v_mfma_f32_16x16x32_bf16 v[208:211], v[64:67], v[36:39], v[208:211]
    v_mfma_f32_16x16x32_bf16 v[212:215], v[68:71], v[36:39], v[212:215]
    v_mfma_f32_16x16x32_bf16 v[216:219], v[72:75], v[36:39], v[216:219]
    v_mfma_f32_16x16x32_bf16 v[220:223], v[76:79], v[36:39], v[220:223]
    s_waitcnt lgkmcnt(10)
    v_mfma_f32_16x16x32_bf16 v[224:227], v[64:67], v[40:43], v[224:227]
    v_mfma_f32_16x16x32_bf16 v[228:231], v[68:71], v[40:43], v[228:231]
    v_mfma_f32_16x16x32_bf16 v[232:235], v[72:75], v[40:43], v[232:235]
    v_mfma_f32_16x16x32_bf16 v[236:239], v[76:79], v[40:43], v[236:239]
    s_waitcnt lgkmcnt(8)
    v_mfma_f32_16x16x32_bf16 v[240:243], v[64:67], v[44:47], v[240:243]
    v_mfma_f32_16x16x32_bf16 v[244:247], v[68:71], v[44:47], v[244:247]
    v_mfma_f32_16x16x32_bf16 v[248:251], v[72:75], v[44:47], v[248:251]
    v_mfma_f32_16x16x32_bf16 v[252:255], v[76:79], v[44:47], v[252:255]
    s_mov_b32 m0, 49152
    s_nop 0
    buffer_load_dwordx4 v16, s[24:27], s50 offen lds
    s_mov_b32 m0, 50176
    s_nop 0
    buffer_load_dwordx4 v17, s[24:27], s50 offen lds
    s_mov_b32 m0, 51200
    s_nop 0
    buffer_load_dwordx4 v20, s[24:27], s50 offen lds
    s_mov_b32 m0, 52224
    s_nop 0
    buffer_load_dwordx4 v21, s[24:27], s50 offen lds
    buffer_load_dwordx4 v[64:67], v2, s[24:27], s51 offen
    buffer_load_dwordx4 v[68:71], v22, s[24:27], s51 offen
    buffer_load_dwordx4 v[72:75], v23, s[24:27], s51 offen
    buffer_load_dwordx4 v[76:79], v24, s[24:27], s51 offen
    s_add_u32 s50, s50, 131072
    s_add_u32 s51, s51, 1024
    s_waitcnt lgkmcnt(6)
    s_waitcnt vmcnt(16)
    ds_read2_b32 v[32:33], v180 offset0:0 offset1:64
    ds_read2_b32 v[34:35], v180 offset0:128 offset1:192
    ds_read2_b32 v[36:37], v181 offset0:0 offset1:64
    ds_read2_b32 v[38:39], v181 offset0:128 offset1:192
    ds_read2_b32 v[40:41], v180 offset0:32 offset1:96
    ds_read2_b32 v[42:43], v180 offset0:160 offset1:224
    ds_read2_b32 v[44:45], v181 offset0:32 offset1:96
    ds_read2_b32 v[46:47], v181 offset0:160 offset1:224
    v_mfma_f32_16x16x32_bf16 v[192:195], v[80:83], v[48:51], v[192:195]
    v_mfma_f32_16x16x32_bf16 v[196:199], v[84:87], v[48:51], v[196:199]
    v_mfma_f32_16x16x32_bf16 v[200:203], v[88:91], v[48:51], v[200:203]
    v_mfma_f32_16x16x32_bf16 v[204:207], v[92:95], v[48:51], v[204:207]
    s_waitcnt lgkmcnt(12)
    v_mfma_f32_16x16x32_bf16 v[208:211], v[80:83], v[52:55], v[208:211]
    v_mfma_f32_16x16x32_bf16 v[212:215], v[84:87], v[52:55], v[212:215]
    v_mfma_f32_16x16x32_bf16 v[216:219], v[88:91], v[52:55], v[216:219]
    v_mfma_f32_16x16x32_bf16 v[220:223], v[92:95], v[52:55], v[220:223]
    s_waitcnt lgkmcnt(10)
    v_mfma_f32_16x16x32_bf16 v[224:227], v[80:83], v[56:59], v[224:227]
    v_mfma_f32_16x16x32_bf16 v[228:231], v[84:87], v[56:59], v[228:231]
    v_mfma_f32_16x16x32_bf16 v[232:235], v[88:91], v[56:59], v[232:235]
    v_mfma_f32_16x16x32_bf16 v[236:239], v[92:95], v[56:59], v[236:239]
    s_waitcnt lgkmcnt(8)
    v_mfma_f32_16x16x32_bf16 v[240:243], v[80:83], v[60:63], v[240:243]
    v_mfma_f32_16x16x32_bf16 v[244:247], v[84:87], v[60:63], v[244:247]
    v_mfma_f32_16x16x32_bf16 v[248:251], v[88:91], v[60:63], v[248:251]
    v_mfma_f32_16x16x32_bf16 v[252:255], v[92:95], v[60:63], v[252:255]
    s_mov_b32 m0, 53248
    s_nop 0
    buffer_load_dwordx4 v16, s[24:27], s50 offen lds
    s_mov_b32 m0, 54272
    s_nop 0
    buffer_load_dwordx4 v17, s[24:27], s50 offen lds
    s_mov_b32 m0, 55296
    s_nop 0
    buffer_load_dwordx4 v20, s[24:27], s50 offen lds
    s_mov_b32 m0, 56320
    s_nop 0
    buffer_load_dwordx4 v21, s[24:27], s50 offen lds
    buffer_load_dwordx4 v[80:83], v2, s[24:27], s51 offen
    buffer_load_dwordx4 v[84:87], v22, s[24:27], s51 offen
    buffer_load_dwordx4 v[88:91], v23, s[24:27], s51 offen
    buffer_load_dwordx4 v[92:95], v24, s[24:27], s51 offen
    s_add_u32 s50, s50, 131072
    s_add_u32 s51, s51, 1024
    s_waitcnt lgkmcnt(6)
    s_waitcnt vmcnt(16)
    ds_read2_b32 v[48:49], v182 offset0:0 offset1:64
    ds_read2_b32 v[50:51], v182 offset0:128 offset1:192
    ds_read2_b32 v[52:53], v183 offset0:0 offset1:64
    ds_read2_b32 v[54:55], v183 offset0:128 offset1:192
    ds_read2_b32 v[56:57], v182 offset0:32 offset1:96
    ds_read2_b32 v[58:59], v182 offset0:160 offset1:224
    ds_read2_b32 v[60:61], v183 offset0:32 offset1:96
    ds_read2_b32 v[62:63], v183 offset0:160 offset1:224
    v_mfma_f32_16x16x32_bf16 v[192:195], v[96:99], v[32:35], v[192:195]
    v_mfma_f32_16x16x32_bf16 v[196:199], v[100:103], v[32:35], v[196:199]
    v_mfma_f32_16x16x32_bf16 v[200:203], v[104:107], v[32:35], v[200:203]
    v_mfma_f32_16x16x32_bf16 v[204:207], v[108:111], v[32:35], v[204:207]
    s_waitcnt lgkmcnt(12)
    v_mfma_f32_16x16x32_bf16 v[208:211], v[96:99], v[36:39], v[208:211]
    v_mfma_f32_16x16x32_bf16 v[212:215], v[100:103], v[36:39], v[212:215]
    v_mfma_f32_16x16x32_bf16 v[216:219], v[104:107], v[36:39], v[216:219]
    v_mfma_f32_16x16x32_bf16 v[220:223], v[108:111], v[36:39], v[220:223]
    s_waitcnt lgkmcnt(10)
    v_mfma_f32_16x16x32_bf16 v[224:227], v[96:99], v[40:43], v[224:227]
    v_mfma_f32_16x16x32_bf16 v[228:231], v[100:103], v[40:43], v[228:231]
    v_mfma_f32_16x16x32_bf16 v[232:235], v[104:107], v[40:43], v[232:235]
    v_mfma_f32_16x16x32_bf16 v[236:239], v[108:111], v[40:43], v[236:239]
    s_waitcnt lgkmcnt(8)
    v_mfma_f32_16x16x32_bf16 v[240:243], v[96:99], v[44:47], v[240:243]
    v_mfma_f32_16x16x32_bf16 v[244:247], v[100:103], v[44:47], v[244:247]
    v_mfma_f32_16x16x32_bf16 v[248:251], v[104:107], v[44:47], v[248:251]
    v_mfma_f32_16x16x32_bf16 v[252:255], v[108:111], v[44:47], v[252:255]
    s_mov_b32 m0, 57344
    s_nop 0
    buffer_load_dwordx4 v16, s[24:27], s50 offen lds
    s_mov_b32 m0, 58368
    s_nop 0
    buffer_load_dwordx4 v17, s[24:27], s50 offen lds
    s_mov_b32 m0, 59392
    s_nop 0
    buffer_load_dwordx4 v20, s[24:27], s50 offen lds
    s_mov_b32 m0, 60416
    s_nop 0
    buffer_load_dwordx4 v21, s[24:27], s50 offen lds
    buffer_load_dwordx4 v[96:99], v2, s[24:27], s51 offen
    buffer_load_dwordx4 v[100:103], v22, s[24:27], s51 offen
    buffer_load_dwordx4 v[104:107], v23, s[24:27], s51 offen
    buffer_load_dwordx4 v[108:111], v24, s[24:27], s51 offen
    s_add_u32 s50, s50, 131072
    s_add_u32 s51, s51, 1024
    s_waitcnt lgkmcnt(6)
    s_waitcnt vmcnt(16)
    ds_read2_b32 v[32:33], v176 offset0:0 offset1:64
    ds_read2_b32 v[34:35], v176 offset0:128 offset1:192
    ds_read2_b32 v[36:37], v177 offset0:0 offset1:64
    ds_read2_b32 v[38:39], v177 offset0:128 offset1:192
    ds_read2_b32 v[40:41], v176 offset0:32 offset1:96
    ds_read2_b32 v[42:43], v176 offset0:160 offset1:224
    ds_read2_b32 v[44:45], v177 offset0:32 offset1:96
    ds_read2_b32 v[46:47], v177 offset0:160 offset1:224
    v_mfma_f32_16x16x32_bf16 v[192:195], v[112:115], v[48:51], v[192:195]
    v_mfma_f32_16x16x32_bf16 v[196:199], v[116:119], v[48:51], v[196:199]
    v_mfma_f32_16x16x32_bf16 v[200:203], v[120:123], v[48:51], v[200:203]
    v_mfma_f32_16x16x32_bf16 v[204:207], v[124:127], v[48:51], v[204:207]
    s_waitcnt lgkmcnt(12)
    v_mfma_f32_16x16x32_bf16 v[208:211], v[112:115], v[52:55], v[208:211]
    v_mfma_f32_16x16x32_bf16 v[212:215], v[116:119], v[52:55], v[212:215]
    v_mfma_f32_16x16x32_bf16 v[216:219], v[120:123], v[52:55], v[216:219]
    v_mfma_f32_16x16x32_bf16 v[220:223], v[124:127], v[52:55], v[220:223]
    s_waitcnt lgkmcnt(10)
    v_mfma_f32_16x16x32_bf16 v[224:227], v[112:115], v[56:59], v[224:227]
    v_mfma_f32_16x16x32_bf16 v[228:231], v[116:119], v[56:59], v[228:231]
    v_mfma_f32_16x16x32_bf16 v[232:235], v[120:123], v[56:59], v[232:235]
    v_mfma_f32_16x16x32_bf16 v[236:239], v[124:127], v[56:59], v[236:239]
    s_waitcnt lgkmcnt(8)
    v_mfma_f32_16x16x32_bf16 v[240:243], v[112:115], v[60:63], v[240:243]
    v_mfma_f32_16x16x32_bf16 v[244:247], v[116:119], v[60:63], v[244:247]
    v_mfma_f32_16x16x32_bf16 v[248:251], v[120:123], v[60:63], v[248:251]
    v_mfma_f32_16x16x32_bf16 v[252:255], v[124:127], v[60:63], v[252:255]
    s_mov_b32 m0, 61440
    s_nop 0
    buffer_load_dwordx4 v16, s[24:27], s50 offen lds
    s_mov_b32 m0, 62464
    s_nop 0
    buffer_load_dwordx4 v17, s[24:27], s50 offen lds
    s_mov_b32 m0, 63488
    s_nop 0
    buffer_load_dwordx4 v20, s[24:27], s50 offen lds
    s_mov_b32 m0, 64512
    s_nop 0
    buffer_load_dwordx4 v21, s[24:27], s50 offen lds
    buffer_load_dwordx4 v[112:115], v2, s[24:27], s51 offen
    buffer_load_dwordx4 v[116:119], v22, s[24:27], s51 offen
    buffer_load_dwordx4 v[120:123], v23, s[24:27], s51 offen
    buffer_load_dwordx4 v[124:127], v24, s[24:27], s51 offen
    s_add_u32 s50, s50, 131072
    s_add_u32 s51, s51, 1024
    s_add_u32 s60, s60, 1
    s_cmp_lt_u32 s60, 3
    s_cbranch_scc1 L2_loop0
    buffer_load_dwordx4 v[8:11], v5, s[12:15], s45 offen
    buffer_load_dwordx4 v[12:15], v5, s[12:15], s45 offen offset:16
    s_waitcnt lgkmcnt(6)
    s_waitcnt vmcnt(18)
    ds_read2_b32 v[48:49], v178 offset0:0 offset1:64
    ds_read2_b32 v[50:51], v178 offset0:128 offset1:192
    ds_read2_b32 v[52:53], v179 offset0:0 offset1:64
    ds_read2_b32 v[54:55], v179 offset0:128 offset1:192
    ds_read2_b32 v[56:57], v178 offset0:32 offset1:96
    ds_read2_b32 v[58:59], v178 offset0:160 offset1:224
    ds_read2_b32 v[60:61], v179 offset0:32 offset1:96
    ds_read2_b32 v[62:63], v179 offset0:160 offset1:224
    v_mfma_f32_16x16x32_bf16 v[192:195], v[64:67], v[32:35], v[192:195]
    v_mfma_f32_16x16x32_bf16 v[196:199], v[68:71], v[32:35], v[196:199]
    v_mfma_f32_16x16x32_bf16 v[200:203], v[72:75], v[32:35], v[200:203]
    v_mfma_f32_16x16x32_bf16 v[204:207], v[76:79], v[32:35], v[204:207]
    s_waitcnt lgkmcnt(12)
    v_mfma_f32_16x16x32_bf16 v[208:211], v[64:67], v[36:39], v[208:211]
    v_mfma_f32_16x16x32_bf16 v[212:215], v[68:71], v[36:39], v[212:215]
    v_mfma_f32_16x16x32_bf16 v[216:219], v[72:75], v[36:39], v[216:219]
    v_mfma_f32_16x16x32_bf16 v[220:223], v[76:79], v[36:39], v[220:223]
    s_waitcnt lgkmcnt(10)
    v_mfma_f32_16x16x32_bf16 v[224:227], v[64:67], v[40:43], v[224:227]
    v_mfma_f32_16x16x32_bf16 v[228:231], v[68:71], v[40:43], v[228:231]
    v_mfma_f32_16x16x32_bf16 v[232:235], v[72:75], v[40:43], v[232:235]
    v_mfma_f32_16x16x32_bf16 v[236:239], v[76:79], v[40:43], v[236:239]
    s_waitcnt lgkmcnt(8)
    v_mfma_f32_16x16x32_bf16 v[240:243], v[64:67], v[44:47], v[240:243]
    v_mfma_f32_16x16x32_bf16 v[244:247], v[68:71], v[44:47], v[244:247]
    v_mfma_f32_16x16x32_bf16 v[248:251], v[72:75], v[44:47], v[248:251]
    v_mfma_f32_16x16x32_bf16 v[252:255], v[76:79], v[44:47], v[252:255]
    s_waitcnt lgkmcnt(6)
    s_waitcnt vmcnt(10)
    ds_read2_b32 v[32:33], v180 offset0:0 offset1:64
    ds_read2_b32 v[34:35], v180 offset0:128 offset1:192
    ds_read2_b32 v[36:37], v181 offset0:0 offset1:64
    ds_read2_b32 v[38:39], v181 offset0:128 offset1:192
    ds_read2_b32 v[40:41], v180 offset0:32 offset1:96
    ds_read2_b32 v[42:43], v180 offset0:160 offset1:224
    ds_read2_b32 v[44:45], v181 offset0:32 offset1:96
    ds_read2_b32 v[46:47], v181 offset0:160 offset1:224
    v_mfma_f32_16x16x32_bf16 v[192:195], v[80:83], v[48:51], v[192:195]
    v_mfma_f32_16x16x32_bf16 v[196:199], v[84:87], v[48:51], v[196:199]
    v_mfma_f32_16x16x32_bf16 v[200:203], v[88:91], v[48:51], v[200:203]
    v_mfma_f32_16x16x32_bf16 v[204:207], v[92:95], v[48:51], v[204:207]
    s_waitcnt lgkmcnt(12)
    v_mfma_f32_16x16x32_bf16 v[208:211], v[80:83], v[52:55], v[208:211]
    v_mfma_f32_16x16x32_bf16 v[212:215], v[84:87], v[52:55], v[212:215]
    v_mfma_f32_16x16x32_bf16 v[216:219], v[88:91], v[52:55], v[216:219]
    v_mfma_f32_16x16x32_bf16 v[220:223], v[92:95], v[52:55], v[220:223]
    s_waitcnt lgkmcnt(10)
    v_mfma_f32_16x16x32_bf16 v[224:227], v[80:83], v[56:59], v[224:227]
    v_mfma_f32_16x16x32_bf16 v[228:231], v[84:87], v[56:59], v[228:231]
    v_mfma_f32_16x16x32_bf16 v[232:235], v[88:91], v[56:59], v[232:235]
    v_mfma_f32_16x16x32_bf16 v[236:239], v[92:95], v[56:59], v[236:239]
    s_waitcnt lgkmcnt(8)
    v_mfma_f32_16x16x32_bf16 v[240:243], v[80:83], v[60:63], v[240:243]
    v_mfma_f32_16x16x32_bf16 v[244:247], v[84:87], v[60:63], v[244:247]
    v_mfma_f32_16x16x32_bf16 v[248:251], v[88:91], v[60:63], v[248:251]
    v_mfma_f32_16x16x32_bf16 v[252:255], v[92:95], v[60:63], v[252:255]
    s_waitcnt lgkmcnt(6)
    s_waitcnt vmcnt(2)
    ds_read2_b32 v[48:49], v182 offset0:0 offset1:64
    ds_read2_b32 v[50:51], v182 offset0:128 offset1:192
    ds_read2_b32 v[52:53], v183 offset0:0 offset1:64
    ds_read2_b32 v[54:55], v183 offset0:128 offset1:192
    ds_read2_b32 v[56:57], v182 offset0:32 offset1:96
    ds_read2_b32 v[58:59], v182 offset0:160 offset1:224
    ds_read2_b32 v[60:61], v183 offset0:32 offset1:96
    ds_read2_b32 v[62:63], v183 offset0:160 offset1:224
    v_mfma_f32_16x16x32_bf16 v[192:195], v[96:99], v[32:35], v[192:195]
    v_mfma_f32_16x16x32_bf16 v[196:199], v[100:103], v[32:35], v[196:199]
    v_mfma_f32_16x16x32_bf16 v[200:203], v[104:107], v[32:35], v[200:203]
    v_mfma_f32_16x16x32_bf16 v[204:207], v[108:111], v[32:35], v[204:207]
    s_waitcnt lgkmcnt(12)
    v_mfma_f32_16x16x32_bf16 v[208:211], v[96:99], v[36:39], v[208:211]
    v_mfma_f32_16x16x32_bf16 v[212:215], v[100:103], v[36:39], v[212:215]
    v_mfma_f32_16x16x32_bf16 v[216:219], v[104:107], v[36:39], v[216:219]
    v_mfma_f32_16x16x32_bf16 v[220:223], v[108:111], v[36:39], v[220:223]
    s_waitcnt lgkmcnt(10)
    v_mfma_f32_16x16x32_bf16 v[224:227], v[96:99], v[40:43], v[224:227]
    v_mfma_f32_16x16x32_bf16 v[228:231], v[100:103], v[40:43], v[228:231]
    v_mfma_f32_16x16x32_bf16 v[232:235], v[104:107], v[40:43], v[232:235]
    v_mfma_f32_16x16x32_bf16 v[236:239], v[108:111], v[40:43], v[236:239]
    s_waitcnt lgkmcnt(8)
    v_mfma_f32_16x16x32_bf16 v[240:243], v[96:99], v[44:47], v[240:243]
    v_mfma_f32_16x16x32_bf16 v[244:247], v[100:103], v[44:47], v[244:247]
    v_mfma_f32_16x16x32_bf16 v[248:251], v[104:107], v[44:47], v[248:251]
    v_mfma_f32_16x16x32_bf16 v[252:255], v[108:111], v[44:47], v[252:255]
    s_waitcnt lgkmcnt(6)
    v_mfma_f32_16x16x32_bf16 v[192:195], v[112:115], v[48:51], v[192:195]
    v_mfma_f32_16x16x32_bf16 v[196:199], v[116:119], v[48:51], v[196:199]
    v_mfma_f32_16x16x32_bf16 v[200:203], v[120:123], v[48:51], v[200:203]
    v_mfma_f32_16x16x32_bf16 v[204:207], v[124:127], v[48:51], v[204:207]
    s_waitcnt lgkmcnt(4)
    v_mfma_f32_16x16x32_bf16 v[208:211], v[112:115], v[52:55], v[208:211]
    v_mfma_f32_16x16x32_bf16 v[212:215], v[116:119], v[52:55], v[212:215]
    v_mfma_f32_16x16x32_bf16 v[216:219], v[120:123], v[52:55], v[216:219]
    v_mfma_f32_16x16x32_bf16 v[220:223], v[124:127], v[52:55], v[220:223]
    s_waitcnt lgkmcnt(2)
    v_mfma_f32_16x16x32_bf16 v[224:227], v[112:115], v[56:59], v[224:227]
    v_mfma_f32_16x16x32_bf16 v[228:231], v[116:119], v[56:59], v[228:231]
    v_mfma_f32_16x16x32_bf16 v[232:235], v[120:123], v[56:59], v[232:235]
    v_mfma_f32_16x16x32_bf16 v[236:239], v[124:127], v[56:59], v[236:239]
    s_waitcnt lgkmcnt(0)
    v_mfma_f32_16x16x32_bf16 v[240:243], v[112:115], v[60:63], v[240:243]
    v_mfma_f32_16x16x32_bf16 v[244:247], v[116:119], v[60:63], v[244:247]
    v_mfma_f32_16x16x32_bf16 v[248:251], v[120:123], v[60:63], v[248:251]
    v_mfma_f32_16x16x32_bf16 v[252:255], v[124:127], v[60:63], v[252:255]
    s_branch L2_epi
L2_main:
    v_lshrrev_b32 v17, 3, v1
    v_bfe_u32 v18, v1, 1, 2
    v_lshrrev_b32 v19, 1, v17
    v_xor_b32 v18, v18, v19
    v_lshlrev_b32 v16, 10, v17
    v_lshl_add_u32 v16, v18, 5, v16
    v_and_b32 v18, 1, v1
    v_lshl_add_u32 v16, v18, 4, v16
    s_lshl_b32 s46, s43, 7
    v_add_u32 v16, s46, v16
    v_add_u32 v17, 8192, v16
    v_add_u32 v18, 16384, v16
    v_add_u32 v19, 24576, v16
    v_add_u32 v26, 57344, v2
    v_add_u32 v27, 114688, v2
    v_add_u32 v28, 172032, v2
    s_sub_u32 s47, s44, 1
    s_mul_i32 s48, s47, 16384
    s_mul_i32 s49, s47, 19
    s_lshl_b32 s50, s49, 15
    s_mul_i32 s51, s42, 224
    s_add_u32 s51, s51, s49
    s_lshl_b32 s51, s51, 10
    s_add_u32 s51, s51, 9437184
    s_waitcnt lgkmcnt(0)
    s_mov_b32 s24, s10
    s_and_b32 s25, s11, 0xffff
    s_mov_b32 s26, 0x10000000
    s_mov_b32 s27, 0x00020000
    s_mov_b32 s16, s6
    s_and_b32 s17, s7, 0xffff
    s_mov_b32 s18, 0x1c0000
    s_mov_b32 s19, 0x00020000
    buffer_load_dwordx4 v[64:67], v2, s[24:27], s51 offen
    buffer_load_dwordx4 v[68:71], v26, s[24:27], s51 offen
    buffer_load_dwordx4 v[72:75], v27, s[24:27], s51 offen
    buffer_load_dwordx4 v[76:79], v28, s[24:27], s51 offen
    s_add_u32 m0, s48, 0
    s_nop 0
    buffer_load_dwordx4 v16, s[16:19], s50 offen lds
    s_add_u32 m0, s48, 1024
    s_nop 0
    buffer_load_dwordx4 v17, s[16:19], s50 offen lds
    s_add_u32 m0, s48, 2048
    s_nop 0
    buffer_load_dwordx4 v18, s[16:19], s50 offen lds
    s_add_u32 m0, s48, 3072
    s_nop 0
    buffer_load_dwordx4 v19, s[16:19], s50 offen lds
    s_add_u32 s50, s50, 32768
    s_add_u32 s51, s51, 1024
    buffer_load_dwordx4 v[80:83], v2, s[24:27], s51 offen
    buffer_load_dwordx4 v[84:87], v26, s[24:27], s51 offen
    buffer_load_dwordx4 v[88:91], v27, s[24:27], s51 offen
    buffer_load_dwordx4 v[92:95], v28, s[24:27], s51 offen
    s_add_u32 m0, s48, 4096
    s_nop 0
    buffer_load_dwordx4 v16, s[16:19], s50 offen lds
    s_add_u32 m0, s48, 5120
    s_nop 0
    buffer_load_dwordx4 v17, s[16:19], s50 offen lds
    s_add_u32 m0, s48, 6144
    s_nop 0
    buffer_load_dwordx4 v18, s[16:19], s50 offen lds
    s_add_u32 m0, s48, 7168
    s_nop 0
    buffer_load_dwordx4 v19, s[16:19], s50 offen lds
    s_add_u32 s50, s50, 32768
    s_add_u32 s51, s51, 1024
    buffer_load_dwordx4 v[96:99], v2, s[24:27], s51 offen
    buffer_load_dwordx4 v[100:103], v26, s[24:27], s51 offen
    buffer_load_dwordx4 v[104:107], v27, s[24:27], s51 offen
    buffer_load_dwordx4 v[108:111], v28, s[24:27], s51 offen
    s_add_u32 m0, s48, 8192
    s_nop 0
    buffer_load_dwordx4 v16, s[16:19], s50 offen lds
    s_add_u32 m0, s48, 9216
    s_nop 0
    buffer_load_dwordx4 v17, s[16:19], s50 offen lds
    s_add_u32 m0, s48, 10240
    s_nop 0
    buffer_load_dwordx4 v18, s[16:19], s50 offen lds
    s_add_u32 m0, s48, 11264
    s_nop 0
    buffer_load_dwordx4 v19, s[16:19], s50 offen lds
    s_add_u32 s50, s50, 32768
    s_add_u32 s51, s51, 1024
    buffer_load_dwordx4 v[112:115], v2, s[24:27], s51 offen
    buffer_load_dwordx4 v[116:119], v26, s[24:27], s51 offen
    buffer_load_dwordx4 v[120:123], v27, s[24:27], s51 offen
    buffer_load_dwordx4 v[124:127], v28, s[24:27], s51 offen
    s_add_u32 m0, s48, 12288
    s_nop 0
    buffer_load_dwordx4 v16, s[16:19], s50 offen lds
    s_add_u32 m0, s48, 13312
    s_nop 0
    buffer_load_dwordx4 v17, s[16:19], s50 offen lds
    s_add_u32 m0, s48, 14336
    s_nop 0
    buffer_load_dwordx4 v18, s[16:19], s50 offen lds
    s_add_u32 m0, s48, 15360
    s_nop 0
    buffer_load_dwordx4 v19, s[16:19], s50 offen lds
    s_add_u32 s50, s50, 32768
    s_add_u32 s51, s51, 1024
    s_mov_b32 s12, s4
    s_and_b32 s13, s5, 0xffff
    s_mov_b32 s14, 0x200000
    s_mov_b32 s15, 0x00020000
    v_lshrrev_b32 v6, 2, v1
    v_and_b32 v7, 3, v1
    v_lshlrev_b32 v5, 10, v6
    v_lshl_add_u32 v5, v7, 5, v5
    s_lshl_b32 s45, s42, 16
    s_lshl_b32 s46, s44, 14
    s_add_u32 s45, s45, s46
    s_lshl_b32 s46, s43, 7
    s_add_u32 s45, s45, s46
    v_bfe_u32 v29, v1, 2, 2
    v_and_b32 v30, 3, v1
    v_and_b32 v31, 1, v4
    v_lshl_add_u32 v31, v31, 2, v29
    v_lshrrev_b32 v25, 1, v4
    v_lshl_add_u32 v25, v25, 4, v31
    v_lshlrev_b32 v24, 7, v25
    v_lshl_add_u32 v24, v30, 3, v24
    v_add_u32 v24, s48, v24
    v_bfe_u32 v31, v31, 1, 2
    v_xor_b32 v29, 0, v31
    v_lshl_add_u32 v20, v29, 5, v24
    v_xor_b32 v29, 1, v31
    v_lshl_add_u32 v21, v29, 5, v24
    v_xor_b32 v29, 2, v31
    v_lshl_add_u32 v22, v29, 5, v24
    v_xor_b32 v29, 3, v31
    v_lshl_add_u32 v23, v29, 5, v24
    v_mov_b32 v192, 0
    v_mov_b32 v193, 0
    v_mov_b32 v194, 0
    v_mov_b32 v195, 0
    v_mov_b32 v196, 0
    v_mov_b32 v197, 0
    v_mov_b32 v198, 0
    v_mov_b32 v199, 0
    v_mov_b32 v200, 0
    v_mov_b32 v201, 0
    v_mov_b32 v202, 0
    v_mov_b32 v203, 0
    v_mov_b32 v204, 0
    v_mov_b32 v205, 0
    v_mov_b32 v206, 0
    v_mov_b32 v207, 0
    v_mov_b32 v208, 0
    v_mov_b32 v209, 0
    v_mov_b32 v210, 0
    v_mov_b32 v211, 0
    v_mov_b32 v212, 0
    v_mov_b32 v213, 0
    v_mov_b32 v214, 0
    v_mov_b32 v215, 0
    v_mov_b32 v216, 0
    v_mov_b32 v217, 0
    v_mov_b32 v218, 0
    v_mov_b32 v219, 0
    v_mov_b32 v220, 0
    v_mov_b32 v221, 0
    v_mov_b32 v222, 0
    v_mov_b32 v223, 0
    v_mov_b32 v224, 0
    v_mov_b32 v225, 0
    v_mov_b32 v226, 0
    v_mov_b32 v227, 0
    v_mov_b32 v228, 0
    v_mov_b32 v229, 0
    v_mov_b32 v230, 0
    v_mov_b32 v231, 0
    v_mov_b32 v232, 0
    v_mov_b32 v233, 0
    v_mov_b32 v234, 0
    v_mov_b32 v235, 0
    v_mov_b32 v236, 0
    v_mov_b32 v237, 0
    v_mov_b32 v238, 0
    v_mov_b32 v239, 0
    v_mov_b32 v240, 0
    v_mov_b32 v241, 0
    v_mov_b32 v242, 0
    v_mov_b32 v243, 0
    v_mov_b32 v244, 0
    v_mov_b32 v245, 0
    v_mov_b32 v246, 0
    v_mov_b32 v247, 0
    v_mov_b32 v248, 0
    v_mov_b32 v249, 0
    v_mov_b32 v250, 0
    v_mov_b32 v251, 0
    v_mov_b32 v252, 0
    v_mov_b32 v253, 0
    v_mov_b32 v254, 0
    v_mov_b32 v255, 0
    s_waitcnt vmcnt(24)
    ds_read_b64_tr_b16 v[32:33], v20 offset:0
    ds_read_b64_tr_b16 v[34:35], v20 offset:1024
    ds_read_b64_tr_b16 v[36:37], v21 offset:0
    ds_read_b64_tr_b16 v[38:39], v21 offset:1024
    ds_read_b64_tr_b16 v[40:41], v22 offset:0
    ds_read_b64_tr_b16 v[42:43], v22 offset:1024
    ds_read_b64_tr_b16 v[44:45], v23 offset:0
    ds_read_b64_tr_b16 v[46:47], v23 offset:1024
    s_mov_b32 s60, 0
L2_loop1:
    s_waitcnt lgkmcnt(6)
    s_waitcnt vmcnt(16)
    ds_read_b64_tr_b16 v[48:49], v20 offset:4096
    ds_read_b64_tr_b16 v[50:51], v20 offset:5120
    ds_read_b64_tr_b16 v[52:53], v21 offset:4096
    ds_read_b64_tr_b16 v[54:55], v21 offset:5120
    ds_read_b64_tr_b16 v[56:57], v22 offset:4096
    ds_read_b64_tr_b16 v[58:59], v22 offset:5120
    ds_read_b64_tr_b16 v[60:61], v23 offset:4096
    ds_read_b64_tr_b16 v[62:63], v23 offset:5120
    v_mfma_f32_16x16x32_bf16 v[192:195], v[32:35], v[64:67], v[192:195]
    v_mfma_f32_16x16x32_bf16 v[208:211], v[32:35], v[68:71], v[208:211]
    v_mfma_f32_16x16x32_bf16 v[224:227], v[32:35], v[72:75], v[224:227]
    v_mfma_f32_16x16x32_bf16 v[240:243], v[32:35], v[76:79], v[240:243]
    s_waitcnt lgkmcnt(12)
    v_mfma_f32_16x16x32_bf16 v[196:199], v[36:39], v[64:67], v[196:199]
    v_mfma_f32_16x16x32_bf16 v[212:215], v[36:39], v[68:71], v[212:215]
    v_mfma_f32_16x16x32_bf16 v[228:231], v[36:39], v[72:75], v[228:231]
    v_mfma_f32_16x16x32_bf16 v[244:247], v[36:39], v[76:79], v[244:247]
    s_waitcnt lgkmcnt(10)
    v_mfma_f32_16x16x32_bf16 v[200:203], v[40:43], v[64:67], v[200:203]
    v_mfma_f32_16x16x32_bf16 v[216:219], v[40:43], v[68:71], v[216:219]
    v_mfma_f32_16x16x32_bf16 v[232:235], v[40:43], v[72:75], v[232:235]
    v_mfma_f32_16x16x32_bf16 v[248:251], v[40:43], v[76:79], v[248:251]
    s_waitcnt lgkmcnt(8)
    v_mfma_f32_16x16x32_bf16 v[204:207], v[44:47], v[64:67], v[204:207]
    v_mfma_f32_16x16x32_bf16 v[220:223], v[44:47], v[68:71], v[220:223]
    v_mfma_f32_16x16x32_bf16 v[236:239], v[44:47], v[72:75], v[236:239]
    v_mfma_f32_16x16x32_bf16 v[252:255], v[44:47], v[76:79], v[252:255]
    buffer_load_dwordx4 v[64:67], v2, s[24:27], s51 offen
    buffer_load_dwordx4 v[68:71], v26, s[24:27], s51 offen
    buffer_load_dwordx4 v[72:75], v27, s[24:27], s51 offen
    buffer_load_dwordx4 v[76:79], v28, s[24:27], s51 offen
    s_add_u32 m0, s48, 0
    s_nop 0
    buffer_load_dwordx4 v16, s[16:19], s50 offen lds
    s_add_u32 m0, s48, 1024
    s_nop 0
    buffer_load_dwordx4 v17, s[16:19], s50 offen lds
    s_add_u32 m0, s48, 2048
    s_nop 0
    buffer_load_dwordx4 v18, s[16:19], s50 offen lds
    s_add_u32 m0, s48, 3072
    s_nop 0
    buffer_load_dwordx4 v19, s[16:19], s50 offen lds
    s_add_u32 s50, s50, 32768
    s_add_u32 s51, s51, 1024
    s_waitcnt lgkmcnt(6)
    s_waitcnt vmcnt(16)
    ds_read_b64_tr_b16 v[32:33], v20 offset:8192
    ds_read_b64_tr_b16 v[34:35], v20 offset:9216
    ds_read_b64_tr_b16 v[36:37], v21 offset:8192
    ds_read_b64_tr_b16 v[38:39], v21 offset:9216
    ds_read_b64_tr_b16 v[40:41], v22 offset:8192
    ds_read_b64_tr_b16 v[42:43], v22 offset:9216
    ds_read_b64_tr_b16 v[44:45], v23 offset:8192
    ds_read_b64_tr_b16 v[46:47], v23 offset:9216
    v_mfma_f32_16x16x32_bf16 v[192:195], v[48:51], v[80:83], v[192:195]
    v_mfma_f32_16x16x32_bf16 v[208:211], v[48:51], v[84:87], v[208:211]
    v_mfma_f32_16x16x32_bf16 v[224:227], v[48:51], v[88:91], v[224:227]
    v_mfma_f32_16x16x32_bf16 v[240:243], v[48:51], v[92:95], v[240:243]
    s_waitcnt lgkmcnt(12)
    v_mfma_f32_16x16x32_bf16 v[196:199], v[52:55], v[80:83], v[196:199]
    v_mfma_f32_16x16x32_bf16 v[212:215], v[52:55], v[84:87], v[212:215]
    v_mfma_f32_16x16x32_bf16 v[228:231], v[52:55], v[88:91], v[228:231]
    v_mfma_f32_16x16x32_bf16 v[244:247], v[52:55], v[92:95], v[244:247]
    s_waitcnt lgkmcnt(10)
    v_mfma_f32_16x16x32_bf16 v[200:203], v[56:59], v[80:83], v[200:203]
    v_mfma_f32_16x16x32_bf16 v[216:219], v[56:59], v[84:87], v[216:219]
    v_mfma_f32_16x16x32_bf16 v[232:235], v[56:59], v[88:91], v[232:235]
    v_mfma_f32_16x16x32_bf16 v[248:251], v[56:59], v[92:95], v[248:251]
    s_waitcnt lgkmcnt(8)
    v_mfma_f32_16x16x32_bf16 v[204:207], v[60:63], v[80:83], v[204:207]
    v_mfma_f32_16x16x32_bf16 v[220:223], v[60:63], v[84:87], v[220:223]
    v_mfma_f32_16x16x32_bf16 v[236:239], v[60:63], v[88:91], v[236:239]
    v_mfma_f32_16x16x32_bf16 v[252:255], v[60:63], v[92:95], v[252:255]
    buffer_load_dwordx4 v[80:83], v2, s[24:27], s51 offen
    buffer_load_dwordx4 v[84:87], v26, s[24:27], s51 offen
    buffer_load_dwordx4 v[88:91], v27, s[24:27], s51 offen
    buffer_load_dwordx4 v[92:95], v28, s[24:27], s51 offen
    s_add_u32 m0, s48, 4096
    s_nop 0
    buffer_load_dwordx4 v16, s[16:19], s50 offen lds
    s_add_u32 m0, s48, 5120
    s_nop 0
    buffer_load_dwordx4 v17, s[16:19], s50 offen lds
    s_add_u32 m0, s48, 6144
    s_nop 0
    buffer_load_dwordx4 v18, s[16:19], s50 offen lds
    s_add_u32 m0, s48, 7168
    s_nop 0
    buffer_load_dwordx4 v19, s[16:19], s50 offen lds
    s_add_u32 s50, s50, 32768
    s_add_u32 s51, s51, 1024
    s_waitcnt lgkmcnt(6)
    s_waitcnt vmcnt(16)
    ds_read_b64_tr_b16 v[48:49], v20 offset:12288
    ds_read_b64_tr_b16 v[50:51], v20 offset:13312
    ds_read_b64_tr_b16 v[52:53], v21 offset:12288
    ds_read_b64_tr_b16 v[54:55], v21 offset:13312
    ds_read_b64_tr_b16 v[56:57], v22 offset:12288
    ds_read_b64_tr_b16 v[58:59], v22 offset:13312
    ds_read_b64_tr_b16 v[60:61], v23 offset:12288
    ds_read_b64_tr_b16 v[62:63], v23 offset:13312
    v_mfma_f32_16x16x32_bf16 v[192:195], v[32:35], v[96:99], v[192:195]
    v_mfma_f32_16x16x32_bf16 v[208:211], v[32:35], v[100:103], v[208:211]
    v_mfma_f32_16x16x32_bf16 v[224:227], v[32:35], v[104:107], v[224:227]
    v_mfma_f32_16x16x32_bf16 v[240:243], v[32:35], v[108:111], v[240:243]
    s_waitcnt lgkmcnt(12)
    v_mfma_f32_16x16x32_bf16 v[196:199], v[36:39], v[96:99], v[196:199]
    v_mfma_f32_16x16x32_bf16 v[212:215], v[36:39], v[100:103], v[212:215]
    v_mfma_f32_16x16x32_bf16 v[228:231], v[36:39], v[104:107], v[228:231]
    v_mfma_f32_16x16x32_bf16 v[244:247], v[36:39], v[108:111], v[244:247]
    s_waitcnt lgkmcnt(10)
    v_mfma_f32_16x16x32_bf16 v[200:203], v[40:43], v[96:99], v[200:203]
    v_mfma_f32_16x16x32_bf16 v[216:219], v[40:43], v[100:103], v[216:219]
    v_mfma_f32_16x16x32_bf16 v[232:235], v[40:43], v[104:107], v[232:235]
    v_mfma_f32_16x16x32_bf16 v[248:251], v[40:43], v[108:111], v[248:251]
    s_waitcnt lgkmcnt(8)
    v_mfma_f32_16x16x32_bf16 v[204:207], v[44:47], v[96:99], v[204:207]
    v_mfma_f32_16x16x32_bf16 v[220:223], v[44:47], v[100:103], v[220:223]
    v_mfma_f32_16x16x32_bf16 v[236:239], v[44:47], v[104:107], v[236:239]
    v_mfma_f32_16x16x32_bf16 v[252:255], v[44:47], v[108:111], v[252:255]
    buffer_load_dwordx4 v[96:99], v2, s[24:27], s51 offen
    buffer_load_dwordx4 v[100:103], v26, s[24:27], s51 offen
    buffer_load_dwordx4 v[104:107], v27, s[24:27], s51 offen
    buffer_load_dwordx4 v[108:111], v28, s[24:27], s51 offen
    s_add_u32 m0, s48, 8192
    s_nop 0
    buffer_load_dwordx4 v16, s[16:19], s50 offen lds
    s_add_u32 m0, s48, 9216
    s_nop 0
    buffer_load_dwordx4 v17, s[16:19], s50 offen lds
    s_add_u32 m0, s48, 10240
    s_nop 0
    buffer_load_dwordx4 v18, s[16:19], s50 offen lds
    s_add_u32 m0, s48, 11264
    s_nop 0
    buffer_load_dwordx4 v19, s[16:19], s50 offen lds
    s_add_u32 s50, s50, 32768
    s_add_u32 s51, s51, 1024
    s_waitcnt lgkmcnt(6)
    s_waitcnt vmcnt(16)
    ds_read_b64_tr_b16 v[32:33], v20 offset:0
    ds_read_b64_tr_b16 v[34:35], v20 offset:1024
    ds_read_b64_tr_b16 v[36:37], v21 offset:0
    ds_read_b64_tr_b16 v[38:39], v21 offset:1024
    ds_read_b64_tr_b16 v[40:41], v22 offset:0
    ds_read_b64_tr_b16 v[42:43], v22 offset:1024
    ds_read_b64_tr_b16 v[44:45], v23 offset:0
    ds_read_b64_tr_b16 v[46:47], v23 offset:1024
    v_mfma_f32_16x16x32_bf16 v[192:195], v[48:51], v[112:115], v[192:195]
    v_mfma_f32_16x16x32_bf16 v[208:211], v[48:51], v[116:119], v[208:211]
    v_mfma_f32_16x16x32_bf16 v[224:227], v[48:51], v[120:123], v[224:227]
    v_mfma_f32_16x16x32_bf16 v[240:243], v[48:51], v[124:127], v[240:243]
    s_waitcnt lgkmcnt(12)
    v_mfma_f32_16x16x32_bf16 v[196:199], v[52:55], v[112:115], v[196:199]
    v_mfma_f32_16x16x32_bf16 v[212:215], v[52:55], v[116:119], v[212:215]
    v_mfma_f32_16x16x32_bf16 v[228:231], v[52:55], v[120:123], v[228:231]
    v_mfma_f32_16x16x32_bf16 v[244:247], v[52:55], v[124:127], v[244:247]
    s_waitcnt lgkmcnt(10)
    v_mfma_f32_16x16x32_bf16 v[200:203], v[56:59], v[112:115], v[200:203]
    v_mfma_f32_16x16x32_bf16 v[216:219], v[56:59], v[116:119], v[216:219]
    v_mfma_f32_16x16x32_bf16 v[232:235], v[56:59], v[120:123], v[232:235]
    v_mfma_f32_16x16x32_bf16 v[248:251], v[56:59], v[124:127], v[248:251]
    s_waitcnt lgkmcnt(8)
    v_mfma_f32_16x16x32_bf16 v[204:207], v[60:63], v[112:115], v[204:207]
    v_mfma_f32_16x16x32_bf16 v[220:223], v[60:63], v[116:119], v[220:223]
    v_mfma_f32_16x16x32_bf16 v[236:239], v[60:63], v[120:123], v[236:239]
    v_mfma_f32_16x16x32_bf16 v[252:255], v[60:63], v[124:127], v[252:255]
    buffer_load_dwordx4 v[112:115], v2, s[24:27], s51 offen
    buffer_load_dwordx4 v[116:119], v26, s[24:27], s51 offen
    buffer_load_dwordx4 v[120:123], v27, s[24:27], s51 offen
    buffer_load_dwordx4 v[124:127], v28, s[24:27], s51 offen
    s_add_u32 m0, s48, 12288
    s_nop 0
    buffer_load_dwordx4 v16, s[16:19], s50 offen lds
    s_add_u32 m0, s48, 13312
    s_nop 0
    buffer_load_dwordx4 v17, s[16:19], s50 offen lds
    s_add_u32 m0, s48, 14336
    s_nop 0
    buffer_load_dwordx4 v18, s[16:19], s50 offen lds
    s_add_u32 m0, s48, 15360
    s_nop 0
    buffer_load_dwordx4 v19, s[16:19], s50 offen lds
    s_add_u32 s50, s50, 32768
    s_add_u32 s51, s51, 1024
    s_add_u32 s60, s60, 1
    s_cmp_lt_u32 s60, 3
    s_cbranch_scc1 L2_loop1
    s_waitcnt lgkmcnt(6)
    s_waitcnt vmcnt(16)
    ds_read_b64_tr_b16 v[48:49], v20 offset:4096
    ds_read_b64_tr_b16 v[50:51], v20 offset:5120
    ds_read_b64_tr_b16 v[52:53], v21 offset:4096
    ds_read_b64_tr_b16 v[54:55], v21 offset:5120
    ds_read_b64_tr_b16 v[56:57], v22 offset:4096
    ds_read_b64_tr_b16 v[58:59], v22 offset:5120
    ds_read_b64_tr_b16 v[60:61], v23 offset:4096
    ds_read_b64_tr_b16 v[62:63], v23 offset:5120
    v_mfma_f32_16x16x32_bf16 v[192:195], v[32:35], v[64:67], v[192:195]
    v_mfma_f32_16x16x32_bf16 v[208:211], v[32:35], v[68:71], v[208:211]
    v_mfma_f32_16x16x32_bf16 v[224:227], v[32:35], v[72:75], v[224:227]
    v_mfma_f32_16x16x32_bf16 v[240:243], v[32:35], v[76:79], v[240:243]
    s_waitcnt lgkmcnt(12)
    v_mfma_f32_16x16x32_bf16 v[196:199], v[36:39], v[64:67], v[196:199]
    v_mfma_f32_16x16x32_bf16 v[212:215], v[36:39], v[68:71], v[212:215]
    v_mfma_f32_16x16x32_bf16 v[228:231], v[36:39], v[72:75], v[228:231]
    v_mfma_f32_16x16x32_bf16 v[244:247], v[36:39], v[76:79], v[244:247]
    s_waitcnt lgkmcnt(10)
    v_mfma_f32_16x16x32_bf16 v[200:203], v[40:43], v[64:67], v[200:203]
    v_mfma_f32_16x16x32_bf16 v[216:219], v[40:43], v[68:71], v[216:219]
    v_mfma_f32_16x16x32_bf16 v[232:235], v[40:43], v[72:75], v[232:235]
    v_mfma_f32_16x16x32_bf16 v[248:251], v[40:43], v[76:79], v[248:251]
    s_waitcnt lgkmcnt(8)
    v_mfma_f32_16x16x32_bf16 v[204:207], v[44:47], v[64:67], v[204:207]
    v_mfma_f32_16x16x32_bf16 v[220:223], v[44:47], v[68:71], v[220:223]
    v_mfma_f32_16x16x32_bf16 v[236:239], v[44:47], v[72:75], v[236:239]
    v_mfma_f32_16x16x32_bf16 v[252:255], v[44:47], v[76:79], v[252:255]
    buffer_load_dwordx4 v[64:67], v2, s[24:27], s51 offen
    buffer_load_dwordx4 v[68:71], v26, s[24:27], s51 offen
    buffer_load_dwordx4 v[72:75], v27, s[24:27], s51 offen
    buffer_load_dwordx4 v[76:79], v28, s[24:27], s51 offen
    s_add_u32 m0, s48, 0
    s_nop 0
    buffer_load_dwordx4 v16, s[16:19], s50 offen lds
    s_add_u32 m0, s48, 1024
    s_nop 0
    buffer_load_dwordx4 v17, s[16:19], s50 offen lds
    s_add_u32 m0, s48, 2048
    s_nop 0
    buffer_load_dwordx4 v18, s[16:19], s50 offen lds
    s_add_u32 m0, s48, 3072
    s_nop 0
    buffer_load_dwordx4 v19, s[16:19], s50 offen lds
    s_add_u32 s50, s50, 32768
    s_add_u32 s51, s51, 1024
    s_waitcnt lgkmcnt(6)
    s_waitcnt vmcnt(16)
    ds_read_b64_tr_b16 v[32:33], v20 offset:8192
    ds_read_b64_tr_b16 v[34:35], v20 offset:9216
    ds_read_b64_tr_b16 v[36:37], v21 offset:8192
    ds_read_b64_tr_b16 v[38:39], v21 offset:9216
    ds_read_b64_tr_b16 v[40:41], v22 offset:8192
    ds_read_b64_tr_b16 v[42:43], v22 offset:9216
    ds_read_b64_tr_b16 v[44:45], v23 offset:8192
    ds_read_b64_tr_b16 v[46:47], v23 offset:9216
    v_mfma_f32_16x16x32_bf16 v[192:195], v[48:51], v[80:83], v[192:195]
    v_mfma_f32_16x16x32_bf16 v[208:211], v[48:51], v[84:87], v[208:211]
    v_mfma_f32_16x16x32_bf16 v[224:227], v[48:51], v[88:91], v[224:227]
    v_mfma_f32_16x16x32_bf16 v[240:243], v[48:51], v[92:95], v[240:243]
    s_waitcnt lgkmcnt(12)
    v_mfma_f32_16x16x32_bf16 v[196:199], v[52:55], v[80:83], v[196:199]
    v_mfma_f32_16x16x32_bf16 v[212:215], v[52:55], v[84:87], v[212:215]
    v_mfma_f32_16x16x32_bf16 v[228:231], v[52:55], v[88:91], v[228:231]
    v_mfma_f32_16x16x32_bf16 v[244:247], v[52:55], v[92:95], v[244:247]
    s_waitcnt lgkmcnt(10)
    v_mfma_f32_16x16x32_bf16 v[200:203], v[56:59], v[80:83], v[200:203]
    v_mfma_f32_16x16x32_bf16 v[216:219], v[56:59], v[84:87], v[216:219]
    v_mfma_f32_16x16x32_bf16 v[232:235], v[56:59], v[88:91], v[232:235]
    v_mfma_f32_16x16x32_bf16 v[248:251], v[56:59], v[92:95], v[248:251]
    s_waitcnt lgkmcnt(8)
    v_mfma_f32_16x16x32_bf16 v[204:207], v[60:63], v[80:83], v[204:207]
    v_mfma_f32_16x16x32_bf16 v[220:223], v[60:63], v[84:87], v[220:223]
    v_mfma_f32_16x16x32_bf16 v[236:239], v[60:63], v[88:91], v[236:239]
    v_mfma_f32_16x16x32_bf16 v[252:255], v[60:63], v[92:95], v[252:255]
    buffer_load_dwordx4 v[80:83], v2, s[24:27], s51 offen
    buffer_load_dwordx4 v[84:87], v26, s[24:27], s51 offen
    buffer_load_dwordx4 v[88:91], v27, s[24:27], s51 offen
    buffer_load_dwordx4 v[92:95], v28, s[24:27], s51 offen
    s_add_u32 m0, s48, 4096
    s_nop 0
    buffer_load_dwordx4 v16, s[16:19], s50 offen lds
    s_add_u32 m0, s48, 5120
    s_nop 0
    buffer_load_dwordx4 v17, s[16:19], s50 offen lds
    s_add_u32 m0, s48, 6144
    s_nop 0
    buffer_load_dwordx4 v18, s[16:19], s50 offen lds
    s_add_u32 m0, s48, 7168
    s_nop 0
    buffer_load_dwordx4 v19, s[16:19], s50 offen lds
    s_add_u32 s50, s50, 32768
    s_add_u32 s51, s51, 1024
    s_waitcnt lgkmcnt(6)
    s_waitcnt vmcnt(16)
    ds_read_b64_tr_b16 v[48:49], v20 offset:12288
    ds_read_b64_tr_b16 v[50:51], v20 offset:13312
    ds_read_b64_tr_b16 v[52:53], v21 offset:12288
    ds_read_b64_tr_b16 v[54:55], v21 offset:13312
    ds_read_b64_tr_b16 v[56:57], v22 offset:12288
    ds_read_b64_tr_b16 v[58:59], v22 offset:13312
    ds_read_b64_tr_b16 v[60:61], v23 offset:12288
    ds_read_b64_tr_b16 v[62:63], v23 offset:13312
    v_mfma_f32_16x16x32_bf16 v[192:195], v[32:35], v[96:99], v[192:195]
    v_mfma_f32_16x16x32_bf16 v[208:211], v[32:35], v[100:103], v[208:211]
    v_mfma_f32_16x16x32_bf16 v[224:227], v[32:35], v[104:107], v[224:227]
    v_mfma_f32_16x16x32_bf16 v[240:243], v[32:35], v[108:111], v[240:243]
    s_waitcnt lgkmcnt(12)
    v_mfma_f32_16x16x32_bf16 v[196:199], v[36:39], v[96:99], v[196:199]
    v_mfma_f32_16x16x32_bf16 v[212:215], v[36:39], v[100:103], v[212:215]
    v_mfma_f32_16x16x32_bf16 v[228:231], v[36:39], v[104:107], v[228:231]
    v_mfma_f32_16x16x32_bf16 v[244:247], v[36:39], v[108:111], v[244:247]
    s_waitcnt lgkmcnt(10)
    v_mfma_f32_16x16x32_bf16 v[200:203], v[40:43], v[96:99], v[200:203]
    v_mfma_f32_16x16x32_bf16 v[216:219], v[40:43], v[100:103], v[216:219]
    v_mfma_f32_16x16x32_bf16 v[232:235], v[40:43], v[104:107], v[232:235]
    v_mfma_f32_16x16x32_bf16 v[248:251], v[40:43], v[108:111], v[248:251]
    s_waitcnt lgkmcnt(8)
    v_mfma_f32_16x16x32_bf16 v[204:207], v[44:47], v[96:99], v[204:207]
    v_mfma_f32_16x16x32_bf16 v[220:223], v[44:47], v[100:103], v[220:223]
    v_mfma_f32_16x16x32_bf16 v[236:239], v[44:47], v[104:107], v[236:239]
    v_mfma_f32_16x16x32_bf16 v[252:255], v[44:47], v[108:111], v[252:255]
    buffer_load_dwordx4 v[96:99], v2, s[24:27], s51 offen
    buffer_load_dwordx4 v[100:103], v26, s[24:27], s51 offen
    buffer_load_dwordx4 v[104:107], v27, s[24:27], s51 offen
    buffer_load_dwordx4 v[108:111], v28, s[24:27], s51 offen
    s_add_u32 m0, s48, 8192
    s_nop 0
    buffer_load_dwordx4 v16, s[16:19], s50 offen lds
    s_add_u32 m0, s48, 9216
    s_nop 0
    buffer_load_dwordx4 v17, s[16:19], s50 offen lds
    s_add_u32 m0, s48, 10240
    s_nop 0
    buffer_load_dwordx4 v18, s[16:19], s50 offen lds
    s_add_u32 m0, s48, 11264
    s_nop 0
    buffer_load_dwordx4 v19, s[16:19], s50 offen lds
    s_add_u32 s50, s50, 32768
    s_add_u32 s51, s51, 1024
    buffer_load_dwordx4 v[8:11], v5, s[12:15], s45 offen
    buffer_load_dwordx4 v[12:15], v5, s[12:15], s45 offen offset:16
    s_waitcnt lgkmcnt(6)
    s_waitcnt vmcnt(18)
    ds_read_b64_tr_b16 v[32:33], v20 offset:0
    ds_read_b64_tr_b16 v[34:35], v20 offset:1024
    ds_read_b64_tr_b16 v[36:37], v21 offset:0
    ds_read_b64_tr_b16 v[38:39], v21 offset:1024
    ds_read_b64_tr_b16 v[40:41], v22 offset:0
    ds_read_b64_tr_b16 v[42:43], v22 offset:1024
    ds_read_b64_tr_b16 v[44:45], v23 offset:0
    ds_read_b64_tr_b16 v[46:47], v23 offset:1024
    v_mfma_f32_16x16x32_bf16 v[192:195], v[48:51], v[112:115], v[192:195]
    v_mfma_f32_16x16x32_bf16 v[208:211], v[48:51], v[116:119], v[208:211]
    v_mfma_f32_16x16x32_bf16 v[224:227], v[48:51], v[120:123], v[224:227]
    v_mfma_f32_16x16x32_bf16 v[240:243], v[48:51], v[124:127], v[240:243]
    s_waitcnt lgkmcnt(12)
    v_mfma_f32_16x16x32_bf16 v[196:199], v[52:55], v[112:115], v[196:199]
    v_mfma_f32_16x16x32_bf16 v[212:215], v[52:55], v[116:119], v[212:215]
    v_mfma_f32_16x16x32_bf16 v[228:231], v[52:55], v[120:123], v[228:231]
    v_mfma_f32_16x16x32_bf16 v[244:247], v[52:55], v[124:127], v[244:247]
    s_waitcnt lgkmcnt(10)
    v_mfma_f32_16x16x32_bf16 v[200:203], v[56:59], v[112:115], v[200:203]
    v_mfma_f32_16x16x32_bf16 v[216:219], v[56:59], v[116:119], v[216:219]
    v_mfma_f32_16x16x32_bf16 v[232:235], v[56:59], v[120:123], v[232:235]
    v_mfma_f32_16x16x32_bf16 v[248:251], v[56:59], v[124:127], v[248:251]
    s_waitcnt lgkmcnt(8)
    v_mfma_f32_16x16x32_bf16 v[204:207], v[60:63], v[112:115], v[204:207]
    v_mfma_f32_16x16x32_bf16 v[220:223], v[60:63], v[116:119], v[220:223]
    v_mfma_f32_16x16x32_bf16 v[236:239], v[60:63], v[120:123], v[236:239]
    v_mfma_f32_16x16x32_bf16 v[252:255], v[60:63], v[124:127], v[252:255]
    s_waitcnt lgkmcnt(6)
    s_waitcnt vmcnt(10)
    ds_read_b64_tr_b16 v[48:49], v20 offset:4096
    ds_read_b64_tr_b16 v[50:51], v20 offset:5120
    ds_read_b64_tr_b16 v[52:53], v21 offset:4096
    ds_read_b64_tr_b16 v[54:55], v21 offset:5120
    ds_read_b64_tr_b16 v[56:57], v22 offset:4096
    ds_read_b64_tr_b16 v[58:59], v22 offset:5120
    ds_read_b64_tr_b16 v[60:61], v23 offset:4096
    ds_read_b64_tr_b16 v[62:63], v23 offset:5120
    v_mfma_f32_16x16x32_bf16 v[192:195], v[32:35], v[64:67], v[192:195]
    v_mfma_f32_16x16x32_bf16 v[208:211], v[32:35], v[68:71], v[208:211]
    v_mfma_f32_16x16x32_bf16 v[224:227], v[32:35], v[72:75], v[224:227]
    v_mfma_f32_16x16x32_bf16 v[240:243], v[32:35], v[76:79], v[240:243]
    s_waitcnt lgkmcnt(12)
    v_mfma_f32_16x16x32_bf16 v[196:199], v[36:39], v[64:67], v[196:199]
    v_mfma_f32_16x16x32_bf16 v[212:215], v[36:39], v[68:71], v[212:215]
    v_mfma_f32_16x16x32_bf16 v[228:231], v[36:39], v[72:75], v[228:231]
    v_mfma_f32_16x16x32_bf16 v[244:247], v[36:39], v[76:79], v[244:247]
    s_waitcnt lgkmcnt(10)
    v_mfma_f32_16x16x32_bf16 v[200:203], v[40:43], v[64:67], v[200:203]
    v_mfma_f32_16x16x32_bf16 v[216:219], v[40:43], v[68:71], v[216:219]
    v_mfma_f32_16x16x32_bf16 v[232:235], v[40:43], v[72:75], v[232:235]
    v_mfma_f32_16x16x32_bf16 v[248:251], v[40:43], v[76:79], v[248:251]
    s_waitcnt lgkmcnt(8)
    v_mfma_f32_16x16x32_bf16 v[204:207], v[44:47], v[64:67], v[204:207]
    v_mfma_f32_16x16x32_bf16 v[220:223], v[44:47], v[68:71], v[220:223]
    v_mfma_f32_16x16x32_bf16 v[236:239], v[44:47], v[72:75], v[236:239]
    v_mfma_f32_16x16x32_bf16 v[252:255], v[44:47], v[76:79], v[252:255]
    s_waitcnt lgkmcnt(6)
    s_waitcnt vmcnt(2)
    ds_read_b64_tr_b16 v[32:33], v20 offset:8192
    ds_read_b64_tr_b16 v[34:35], v20 offset:9216
    ds_read_b64_tr_b16 v[36:37], v21 offset:8192
    ds_read_b64_tr_b16 v[38:39], v21 offset:9216
    ds_read_b64_tr_b16 v[40:41], v22 offset:8192
    ds_read_b64_tr_b16 v[42:43], v22 offset:9216
    ds_read_b64_tr_b16 v[44:45], v23 offset:8192
    ds_read_b64_tr_b16 v[46:47], v23 offset:9216
    v_mfma_f32_16x16x32_bf16 v[192:195], v[48:51], v[80:83], v[192:195]
    v_mfma_f32_16x16x32_bf16 v[208:211], v[48:51], v[84:87], v[208:211]
    v_mfma_f32_16x16x32_bf16 v[224:227], v[48:51], v[88:91], v[224:227]
    v_mfma_f32_16x16x32_bf16 v[240:243], v[48:51], v[92:95], v[240:243]
    s_waitcnt lgkmcnt(12)
    v_mfma_f32_16x16x32_bf16 v[196:199], v[52:55], v[80:83], v[196:199]
    v_mfma_f32_16x16x32_bf16 v[212:215], v[52:55], v[84:87], v[212:215]
    v_mfma_f32_16x16x32_bf16 v[228:231], v[52:55], v[88:91], v[228:231]
    v_mfma_f32_16x16x32_bf16 v[244:247], v[52:55], v[92:95], v[244:247]
    s_waitcnt lgkmcnt(10)
    v_mfma_f32_16x16x32_bf16 v[200:203], v[56:59], v[80:83], v[200:203]
    v_mfma_f32_16x16x32_bf16 v[216:219], v[56:59], v[84:87], v[216:219]
    v_mfma_f32_16x16x32_bf16 v[232:235], v[56:59], v[88:91], v[232:235]
    v_mfma_f32_16x16x32_bf16 v[248:251], v[56:59], v[92:95], v[248:251]
    s_waitcnt lgkmcnt(8)
    v_mfma_f32_16x16x32_bf16 v[204:207], v[60:63], v[80:83], v[204:207]
    v_mfma_f32_16x16x32_bf16 v[220:223], v[60:63], v[84:87], v[220:223]
    v_mfma_f32_16x16x32_bf16 v[236:239], v[60:63], v[88:91], v[236:239]
    v_mfma_f32_16x16x32_bf16 v[252:255], v[60:63], v[92:95], v[252:255]
    s_cmp_eq_u32 s44, 3
    s_cbranch_scc1 L2_epi
    s_waitcnt lgkmcnt(6)
    v_mfma_f32_16x16x32_bf16 v[192:195], v[32:35], v[96:99], v[192:195]
    v_mfma_f32_16x16x32_bf16 v[208:211], v[32:35], v[100:103], v[208:211]
    v_mfma_f32_16x16x32_bf16 v[224:227], v[32:35], v[104:107], v[224:227]
    v_mfma_f32_16x16x32_bf16 v[240:243], v[32:35], v[108:111], v[240:243]
    s_waitcnt lgkmcnt(4)
    v_mfma_f32_16x16x32_bf16 v[196:199], v[36:39], v[96:99], v[196:199]
    v_mfma_f32_16x16x32_bf16 v[212:215], v[36:39], v[100:103], v[212:215]
    v_mfma_f32_16x16x32_bf16 v[228:231], v[36:39], v[104:107], v[228:231]
    v_mfma_f32_16x16x32_bf16 v[244:247], v[36:39], v[108:111], v[244:247]
    s_waitcnt lgkmcnt(2)
    v_mfma_f32_16x16x32_bf16 v[200:203], v[40:43], v[96:99], v[200:203]
    v_mfma_f32_16x16x32_bf16 v[216:219], v[40:43], v[100:103], v[216:219]
    v_mfma_f32_16x16x32_bf16 v[232:235], v[40:43], v[104:107], v[232:235]
    v_mfma_f32_16x16x32_bf16 v[248:251], v[40:43], v[108:111], v[248:251]
    s_waitcnt lgkmcnt(0)
    v_mfma_f32_16x16x32_bf16 v[204:207], v[44:47], v[96:99], v[204:207]
    v_mfma_f32_16x16x32_bf16 v[220:223], v[44:47], v[100:103], v[220:223]
    v_mfma_f32_16x16x32_bf16 v[236:239], v[44:47], v[104:107], v[236:239]
    v_mfma_f32_16x16x32_bf16 v[252:255], v[44:47], v[108:111], v[252:255]
L2_epi:
    s_waitcnt vmcnt(0) lgkmcnt(0)
    s_mov_b32 s20, s8
    s_and_b32 s21, s9, 0xffff
    s_mov_b32 s22, 0x200000
    s_mov_b32 s23, 0x00020000
    v_lshrrev_b32 v3, 2, v1
    v_and_b32 v4, 3, v1
    s_mul_i32 s46, s44, 17408
    s_add_u32 s46, s46, 65536
    v_add_u32 v6, s46, v2
    s_mul_i32 s46, s44, 4352
    s_add_u32 s46, s46, 65536
    v_mul_u32_u24 v7, 1088, v4
    v_lshl_add_u32 v7, v3, 4, v7
    v_add_u32 v7, s46, v7
    s_nop 3
    ds_write_b128 v6, v[192:195] offset:0
    ds_write_b128 v6, v[196:199] offset:1088
    ds_write_b128 v6, v[200:203] offset:2176
    ds_write_b128 v6, v[204:207] offset:3264
    ds_write_b128 v6, v[208:211] offset:4352
    ds_write_b128 v6, v[212:215] offset:5440
    ds_write_b128 v6, v[216:219] offset:6528
    ds_write_b128 v6, v[220:223] offset:7616
    ds_write_b128 v6, v[224:227] offset:8704
    ds_write_b128 v6, v[228:231] offset:9792
    ds_write_b128 v6, v[232:235] offset:10880
    ds_write_b128 v6, v[236:239] offset:11968
    ds_write_b128 v6, v[240:243] offset:13056
    ds_write_b128 v6, v[244:247] offset:14144
    ds_write_b128 v6, v[248:251] offset:15232
    ds_write_b128 v6, v[252:255] offset:16320
    s_waitcnt lgkmcnt(0)
    s_barrier
    ds_read_b128 v[80:83], v7 offset:17408
    ds_read_b128 v[84:87], v7 offset:17664
    ds_read_b128 v[88:91], v7 offset:17920
    ds_read_b128 v[92:95], v7 offset:18176
    ds_read_b128 v[96:99], v7 offset:34816
    ds_read_b128 v[100:103], v7 offset:35072
    ds_read_b128 v[104:107], v7 offset:35328
    ds_read_b128 v[108:111], v7 offset:35584
    ds_read_b128 v[112:115], v7 offset:52224
    ds_read_b128 v[116:119], v7 offset:52480
    ds_read_b128 v[120:123], v7 offset:52736
    ds_read_b128 v[124:127], v7 offset:52992
    s_waitcnt lgkmcnt(4)
    ds_read_b128 v[64:67], v7 offset:0
    ds_read_b128 v[68:71], v7 offset:256
    ds_read_b128 v[72:75], v7 offset:512
    ds_read_b128 v[76:79], v7 offset:768
    v_pk_add_f32 v[80:81], v[80:81], v[96:97]
    v_pk_add_f32 v[82:83], v[82:83], v[98:99]
    v_pk_add_f32 v[84:85], v[84:85], v[100:101]
    v_pk_add_f32 v[86:87], v[86:87], v[102:103]
    v_pk_add_f32 v[88:89], v[88:89], v[104:105]
    v_pk_add_f32 v[90:91], v[90:91], v[106:107]
    v_pk_add_f32 v[92:93], v[92:93], v[108:109]
    v_pk_add_f32 v[94:95], v[94:95], v[110:111]
    s_waitcnt lgkmcnt(4)
    v_pk_add_f32 v[80:81], v[80:81], v[112:113]
    v_pk_add_f32 v[82:83], v[82:83], v[114:115]
    v_pk_add_f32 v[84:85], v[84:85], v[116:117]
    v_pk_add_f32 v[86:87], v[86:87], v[118:119]
    v_pk_add_f32 v[88:89], v[88:89], v[120:121]
    v_pk_add_f32 v[90:91], v[90:91], v[122:123]
    v_pk_add_f32 v[92:93], v[92:93], v[124:125]
    v_pk_add_f32 v[94:95], v[94:95], v[126:127]
    v_cvt_pk_bf16_f32 v96, v80, v81
    v_cvt_pk_bf16_f32 v97, v82, v83
    v_cvt_pk_bf16_f32 v98, v84, v85
    v_cvt_pk_bf16_f32 v99, v86, v87
    v_cvt_pk_bf16_f32 v100, v88, v89
    v_cvt_pk_bf16_f32 v101, v90, v91
    v_cvt_pk_bf16_f32 v102, v92, v93
    v_cvt_pk_bf16_f32 v103, v94, v95
    v_lshlrev_b32 v80, 16, v96
    v_and_b32 v81, 0xffff0000, v96
    v_lshlrev_b32 v82, 16, v97
    v_and_b32 v83, 0xffff0000, v97
    v_lshlrev_b32 v84, 16, v98
    v_and_b32 v85, 0xffff0000, v98
    v_lshlrev_b32 v86, 16, v99
    v_and_b32 v87, 0xffff0000, v99
    v_lshlrev_b32 v88, 16, v100
    v_and_b32 v89, 0xffff0000, v100
    v_lshlrev_b32 v90, 16, v101
    v_and_b32 v91, 0xffff0000, v101
    v_lshlrev_b32 v92, 16, v102
    v_and_b32 v93, 0xffff0000, v102
    v_lshlrev_b32 v94, 16, v103
    v_and_b32 v95, 0xffff0000, v103
    v_mul_f32 v112, 0xbfb8aa3b, v80
    v_mul_f32 v113, 0xbfb8aa3b, v81
    v_mul_f32 v114, 0xbfb8aa3b, v82
    v_mul_f32 v115, 0xbfb8aa3b, v83
    v_mul_f32 v116, 0xbfb8aa3b, v84
    v_mul_f32 v117, 0xbfb8aa3b, v85
    v_mul_f32 v118, 0xbfb8aa3b, v86
    v_mul_f32 v119, 0xbfb8aa3b, v87
    v_mul_f32 v120, 0xbfb8aa3b, v88
    v_mul_f32 v121, 0xbfb8aa3b, v89
    v_mul_f32 v122, 0xbfb8aa3b, v90
    v_mul_f32 v123, 0xbfb8aa3b, v91
    v_mul_f32 v124, 0xbfb8aa3b, v92
    v_mul_f32 v125, 0xbfb8aa3b, v93
    v_mul_f32 v126, 0xbfb8aa3b, v94
    v_mul_f32 v127, 0xbfb8aa3b, v95
    v_exp_f32 v112, v112
    v_exp_f32 v113, v113
    v_exp_f32 v114, v114
    v_exp_f32 v115, v115
    v_exp_f32 v116, v116
    v_exp_f32 v117, v117
    v_exp_f32 v118, v118
    v_exp_f32 v119, v119
    v_exp_f32 v120, v120
    v_exp_f32 v121, v121
    v_exp_f32 v122, v122
    v_exp_f32 v123, v123
    v_exp_f32 v124, v124
    v_exp_f32 v125, v125
    v_exp_f32 v126, v126
    v_exp_f32 v127, v127
    v_add_f32 v112, 1.0, v112
    v_add_f32 v113, 1.0, v113
    v_add_f32 v114, 1.0, v114
    v_add_f32 v115, 1.0, v115
    v_add_f32 v116, 1.0, v116
    v_add_f32 v117, 1.0, v117
    v_add_f32 v118, 1.0, v118
    v_add_f32 v119, 1.0, v119
    v_add_f32 v120, 1.0, v120
    v_add_f32 v121, 1.0, v121
    v_add_f32 v122, 1.0, v122
    v_add_f32 v123, 1.0, v123
    v_add_f32 v124, 1.0, v124
    v_add_f32 v125, 1.0, v125
    v_add_f32 v126, 1.0, v126
    v_add_f32 v127, 1.0, v127
    v_rcp_f32 v112, v112
    v_rcp_f32 v113, v113
    v_rcp_f32 v114, v114
    v_rcp_f32 v115, v115
    v_rcp_f32 v116, v116
    v_rcp_f32 v117, v117
    v_rcp_f32 v118, v118
    v_rcp_f32 v119, v119
    v_rcp_f32 v120, v120
    v_rcp_f32 v121, v121
    v_rcp_f32 v122, v122
    v_rcp_f32 v123, v123
    v_rcp_f32 v124, v124
    v_rcp_f32 v125, v125
    v_rcp_f32 v126, v126
    v_rcp_f32 v127, v127
    v_pk_mul_f32 v[80:81], v[80:81], v[112:113]
    v_pk_mul_f32 v[82:83], v[82:83], v[114:115]
    v_pk_mul_f32 v[84:85], v[84:85], v[116:117]
    v_pk_mul_f32 v[86:87], v[86:87], v[118:119]
    v_pk_mul_f32 v[88:89], v[88:89], v[120:121]
    v_pk_mul_f32 v[90:91], v[90:91], v[122:123]
    v_pk_mul_f32 v[92:93], v[92:93], v[124:125]
    v_pk_mul_f32 v[94:95], v[94:95], v[126:127]
    v_cvt_pk_bf16_f32 v96, v80, v81
    v_cvt_pk_bf16_f32 v97, v82, v83
    v_cvt_pk_bf16_f32 v98, v84, v85
    v_cvt_pk_bf16_f32 v99, v86, v87
    v_cvt_pk_bf16_f32 v100, v88, v89
    v_cvt_pk_bf16_f32 v101, v90, v91
    v_cvt_pk_bf16_f32 v102, v92, v93
    v_cvt_pk_bf16_f32 v103, v94, v95
    s_waitcnt lgkmcnt(0)
    v_cvt_pk_bf16_f32 v104, v64, v65
    v_cvt_pk_bf16_f32 v105, v66, v67
    v_cvt_pk_bf16_f32 v106, v68, v69
    v_cvt_pk_bf16_f32 v107, v70, v71
    v_cvt_pk_bf16_f32 v108, v72, v73
    v_cvt_pk_bf16_f32 v109, v74, v75
    v_cvt_pk_bf16_f32 v110, v76, v77
    v_cvt_pk_bf16_f32 v111, v78, v79
    v_lshlrev_b32 v80, 16, v96
    v_and_b32 v81, 0xffff0000, v96
    v_lshlrev_b32 v64, 16, v104
    v_and_b32 v65, 0xffff0000, v104
    v_lshlrev_b32 v82, 16, v97
    v_and_b32 v83, 0xffff0000, v97
    v_lshlrev_b32 v66, 16, v105
    v_and_b32 v67, 0xffff0000, v105
    v_lshlrev_b32 v84, 16, v98
    v_and_b32 v85, 0xffff0000, v98
    v_lshlrev_b32 v68, 16, v106
    v_and_b32 v69, 0xffff0000, v106
    v_lshlrev_b32 v86, 16, v99
    v_and_b32 v87, 0xffff0000, v99
    v_lshlrev_b32 v70, 16, v107
    v_and_b32 v71, 0xffff0000, v107
    v_lshlrev_b32 v88, 16, v100
    v_and_b32 v89, 0xffff0000, v100
    v_lshlrev_b32 v72, 16, v108
    v_and_b32 v73, 0xffff0000, v108
    v_lshlrev_b32 v90, 16, v101
    v_and_b32 v91, 0xffff0000, v101
    v_lshlrev_b32 v74, 16, v109
    v_and_b32 v75, 0xffff0000, v109
    v_lshlrev_b32 v92, 16, v102
    v_and_b32 v93, 0xffff0000, v102
    v_lshlrev_b32 v76, 16, v110
    v_and_b32 v77, 0xffff0000, v110
    v_lshlrev_b32 v94, 16, v103
    v_and_b32 v95, 0xffff0000, v103
    v_lshlrev_b32 v78, 16, v111
    v_and_b32 v79, 0xffff0000, v111
    v_pk_mul_f32 v[80:81], v[80:81], v[64:65]
    v_pk_mul_f32 v[82:83], v[82:83], v[66:67]
    v_pk_mul_f32 v[84:85], v[84:85], v[68:69]
    v_pk_mul_f32 v[86:87], v[86:87], v[70:71]
    v_pk_mul_f32 v[88:89], v[88:89], v[72:73]
    v_pk_mul_f32 v[90:91], v[90:91], v[74:75]
    v_pk_mul_f32 v[92:93], v[92:93], v[76:77]
    v_pk_mul_f32 v[94:95], v[94:95], v[78:79]
    v_cvt_pk_bf16_f32 v96, v80, v81
    v_cvt_pk_bf16_f32 v97, v82, v83
    v_cvt_pk_bf16_f32 v98, v84, v85
    v_cvt_pk_bf16_f32 v99, v86, v87
    v_cvt_pk_bf16_f32 v100, v88, v89
    v_cvt_pk_bf16_f32 v101, v90, v91
    v_cvt_pk_bf16_f32 v102, v92, v93
    v_cvt_pk_bf16_f32 v103, v94, v95
    v_lshlrev_b32 v80, 16, v96
    v_and_b32 v81, 0xffff0000, v96
    v_lshlrev_b32 v64, 16, v8
    v_and_b32 v65, 0xffff0000, v8
    v_lshlrev_b32 v82, 16, v97
    v_and_b32 v83, 0xffff0000, v97
    v_lshlrev_b32 v66, 16, v9
    v_and_b32 v67, 0xffff0000, v9
    v_lshlrev_b32 v84, 16, v98
    v_and_b32 v85, 0xffff0000, v98
    v_lshlrev_b32 v68, 16, v10
    v_and_b32 v69, 0xffff0000, v10
    v_lshlrev_b32 v86, 16, v99
    v_and_b32 v87, 0xffff0000, v99
    v_lshlrev_b32 v70, 16, v11
    v_and_b32 v71, 0xffff0000, v11
    v_lshlrev_b32 v88, 16, v100
    v_and_b32 v89, 0xffff0000, v100
    v_lshlrev_b32 v72, 16, v12
    v_and_b32 v73, 0xffff0000, v12
    v_lshlrev_b32 v90, 16, v101
    v_and_b32 v91, 0xffff0000, v101
    v_lshlrev_b32 v74, 16, v13
    v_and_b32 v75, 0xffff0000, v13
    v_lshlrev_b32 v92, 16, v102
    v_and_b32 v93, 0xffff0000, v102
    v_lshlrev_b32 v76, 16, v14
    v_and_b32 v77, 0xffff0000, v14
    v_lshlrev_b32 v94, 16, v103
    v_and_b32 v95, 0xffff0000, v103
    v_lshlrev_b32 v78, 16, v15
    v_and_b32 v79, 0xffff0000, v15
    v_pk_add_f32 v[80:81], v[80:81], v[64:65]
    v_pk_add_f32 v[82:83], v[82:83], v[66:67]
    v_pk_add_f32 v[84:85], v[84:85], v[68:69]
    v_pk_add_f32 v[86:87], v[86:87], v[70:71]
    v_pk_add_f32 v[88:89], v[88:89], v[72:73]
    v_pk_add_f32 v[90:91], v[90:91], v[74:75]
    v_pk_add_f32 v[92:93], v[92:93], v[76:77]
    v_pk_add_f32 v[94:95], v[94:95], v[78:79]
    v_cvt_pk_bf16_f32 v96, v80, v81
    v_cvt_pk_bf16_f32 v97, v82, v83
    v_cvt_pk_bf16_f32 v98, v84, v85
    v_cvt_pk_bf16_f32 v99, v86, v87
    v_cvt_pk_bf16_f32 v100, v88, v89
    v_cvt_pk_bf16_f32 v101, v90, v91
    v_cvt_pk_bf16_f32 v102, v92, v93
    v_cvt_pk_bf16_f32 v103, v94, v95
    buffer_store_dwordx4 v[96:99], v5, s[20:23], s45 offen
    buffer_store_dwordx4 v[100:103], v5, s[20:23], s45 offen offset:16
L2_end:
    s_endpgm

.section .rodata,"a"
.p2align 6
.amdhsa_kernel l2_kernel
  .amdhsa_next_free_vgpr 256
  .amdhsa_next_free_sgpr 96
  .amdhsa_accum_offset 256
  .amdhsa_group_segment_fixed_size 0
  .amdhsa_kernarg_size 80
  .amdhsa_user_sgpr_count 2
  .amdhsa_user_sgpr_kernarg_segment_ptr 1
  .amdhsa_system_sgpr_workgroup_id_x 1
  .amdhsa_float_denorm_mode_32 3
.end_amdhsa_kernel
.text
code_end:
.set CODE_BYTES, code_end-l1_kernel
.set CODE_WGS, (CODE_BYTES+32767)/32768
```
